```python
import torch

def _softmax(x, axis=-1):
    return torch.softmax(x, dim=axis)
def _gelu(x):
    return torch.nn.functional.gelu(x, approximate="tanh")
def _silu(x):
    return torch.nn.functional.silu(x)
def _sigmoid(x):
    return torch.sigmoid(x)
def _layernorm(x, axis=-1, eps=1e-5):
    m = x.mean(dim=axis, keepdim=True)
    v = x.var(dim=axis, keepdim=True, unbiased=False)
    return (x - m) / torch.sqrt(v + eps)
def _scatter_add(tgt, idx, src, axis=0):
    return tgt.clone().index_add_(axis, idx, src)
def _segment_sum(src, seg, n):
    out = torch.zeros((n,) + src.shape[1:], dtype=src.dtype)
    return out.index_add_(0, seg, src)
def _pad(x, pw):
    flat = tuple(v for pair in reversed(pw) for v in pair)
    return torch.nn.functional.pad(x, flat)

kernel_name = 'parallel_sum__linear_kernel_hedgehog__mixer_token_mlp__prompt'

def setup_inputs():

    _w = (lambda a: (lambda t: t.to(torch.bfloat16) if t.is_floating_point() else t)(torch.as_tensor(a)))
    def _A_setup():
        B, S, D, H = 1, 2048, 448, 16
        Dh = D // H
        return {
            "x": _w((lambda *s: torch.randn(*s, dtype=torch.bfloat16) * 0.05)(B, S, D)),
            "wqkv": _w((lambda *s: torch.randn(*s, dtype=torch.bfloat16) * 0.2)(D, 3 * D)),
            "w_phi": _w((lambda *s: torch.randn(*s, dtype=torch.bfloat16) * 0.2)(H, Dh, Dh) * (Dh ** -0.5)),
            "wo": _w((lambda *s: torch.randn(*s, dtype=torch.bfloat16) * 0.05)(D, D)),
        }
    _A_in = _A_setup()

    def _B_setup():
        B, S, D, F = 1, 2048, 448, 1792
        return {
            "x": _w((lambda *s: torch.randn(*s, dtype=torch.bfloat16) * 0.05)(B, S, D)),
            "w1": _w((lambda *s: torch.randn(*s, dtype=torch.bfloat16) * 0.8)(S, F) * (S ** -0.5)),
            "b1": _w((lambda *s: torch.randn(*s, dtype=torch.bfloat16) * 3.2)(F) * 0.02),
            "w2": _w((lambda *s: torch.randn(*s, dtype=torch.bfloat16) * 0.4)(F, S) * (F ** -0.5)),
            "b2": _w((lambda *s: torch.randn(*s, dtype=torch.bfloat16) * 1.6)(S) * 0.02),
        }
    _B_in = _B_setup()

    return {
        "A_x": _A_in["x"],
        "A_wqkv": _A_in["wqkv"],
        "A_w_phi": _A_in["w_phi"],
        "A_wo": _A_in["wo"],
        "B_x": _B_in["x"],
        "B_w1": _B_in["w1"],
        "B_b1": _B_in["b1"],
        "B_w2": _B_in["w2"],
        "B_b2": _B_in["b2"],
    }

def reference(A_x, A_wqkv, A_w_phi, A_wo, B_x, B_w1, B_b1, B_w2, B_b2):
    def _A_ref(x, wqkv, w_phi, wo):
        B, S, D = x.shape
        H = 16; Dh = D // H
        qkv = (lambda x, *d: x.permute(*d))((x @ wqkv).reshape(B, S, 3, H, Dh), 2, 0, 3, 1, 4)
        q, k, v = qkv[0], qkv[1], qkv[2]
        pq = torch.einsum("bhsd,hdf->bhsf", q, w_phi)
        pk = torch.einsum("bhsd,hdf->bhsf", k, w_phi)
        phi_q = torch.concatenate([_softmax(pq, axis=-1), _softmax(-pq, axis=-1)], axis=-1)
        phi_k = torch.concatenate([_softmax(pk, axis=-1), _softmax(-pk, axis=-1)], axis=-1)
        kv = torch.einsum("bhsf,bhsd->bhfd", phi_k, v)
        z  = torch.einsum("bhsf->bhf", phi_k)
        num = torch.einsum("bhqf,bhfd->bhqd", phi_q, kv)
        den = torch.einsum("bhqf,bhf->bhq", phi_q, z)[..., None] + 1e-6
        o = num / den
        return (lambda x, *d: x.permute(*d))(o, 0, 2, 1, 3).reshape(B, S, D) @ wo

    def _B_ref(x, w1, b1, w2, b2):
        B, S, D = x.shape
        h = _layernorm(x, axis=-1)
        u = torch.einsum("bsd,sf->bdf", h, w1) + b1
        u = _gelu(u)
        y = torch.einsum("bdf,fs->bds", u, w2) + b2
        return (lambda x, *d: x.permute(*d))(y, 0, 2, 1)

    x = A_x
    xn = _layernorm(x, axis=-1)
    return x + _A_ref(xn, A_wqkv, A_w_phi, A_wo) + _B_ref(xn, B_w1, B_b1, B_w2, B_b2)
```

```asm
; @launch grid=(256,1,1) block=(256,1,1) lds=163840
.amdgcn_target "amdgcn-amd-amdhsa--gfx950"
.text
.globl parallel_sum__linear_kernel_hedgehog__mixer_token_mlp__prompt_kernel
.p2align 8
.type parallel_sum__linear_kernel_hedgehog__mixer_token_mlp__prompt_kernel,@function
parallel_sum__linear_kernel_hedgehog__mixer_token_mlp__prompt_kernel:
L_start:
    s_load_dwordx2 s[8:9], s[0:1], 0
    s_cmp_ge_u32 s2, 256
    s_cbranch_scc1 L_end
    s_load_dwordx2 s[12:13], s[0:1], 8
    s_load_dwordx2 s[16:17], s[0:1], 16
    s_load_dwordx2 s[24:25], s[0:1], 40
    s_load_dwordx2 s[44:45], s[0:1], 88
    s_load_dwordx2 s[20:21], s[0:1], 24
    s_load_dwordx2 s[28:29], s[0:1], 48
    s_load_dwordx2 s[32:33], s[0:1], 56
    s_load_dwordx2 s[36:37], s[0:1], 64
    s_load_dwordx2 s[40:41], s[0:1], 72
    v_lshrrev_b32 v240, 5, v0
    v_and_b32 v241, 31, v0
    v_mul_u32_u24 v10, 896, v240
    v_lshl_add_u32 v10, v241, 4, v10
    v_cmp_gt_u32 vcc, 28, v241
    v_mov_b32 v11, 0x80000000
    s_mov_b32 s10, 1835008
    s_mov_b32 s11, 0x20000
    v_cndmask_b32 v10, v11, v10, vcc
    s_mul_i32 s65, s2, 7168
    v_lshrrev_b32 v1, 6, v0
    v_and_b32 v0, 63, v0
    s_waitcnt lgkmcnt(0)
    buffer_load_dwordx4 v[16:19], v10, s[8:11], s65 offen
    buffer_load_dwordx4 v[20:23], v10, s[8:11], s65 offen offset:448
    s_load_dword s51, s[44:45], 16384
    v_readfirstlane_b32 s48, v1
    v_cndmask_b32 v15, 0, 1.0, vcc
    v_lshlrev_b32 v1, 4, v0
    v_lshrrev_b32 v240, 5, v0
    s_and_b32 s49, s2, 7
    s_lshr_b32 s50, s2, 3
    s_lshl_b32 s67, s50, 2
    s_add_u32 s67, s67, s48
    s_getpc_b64 s[76:77]
L_pc:
    s_lshl_b32 s66, s67, 8
    v_lshl_add_u32 v2, v240, 7, s66
    v_min_u32 v2, L_end-L_pc, v2
    global_load_dword v255, v2, s[76:77]
    s_mov_b32 s14, 1204224
    s_mov_b32 s15, 0x20000
    s_mov_b32 s18, 25088
    s_mov_b32 s19, 0x20000
    s_mov_b32 s0, 0xffff0000
    s_mov_b32 s70, 0
    s_mov_b32 s71, -1
    s_mul_i32 s63, s49, 28
    s_min_u32 s62, s50, 27
    s_add_u32 s63, s63, s62
    s_and_b32 s62, s63, 15
    s_lshr_b32 s63, s63, 4
    v_and_b32 v12, 0x13, v241
    v_and_b32 v13, 4, v241
    v_lshl_or_b32 v12, v13, 1, v12
    v_and_b32 v13, 8, v241
    v_lshrrev_b32 v13, 1, v13
    v_or_b32 v12, v12, v13
    v_mul_u32_u24 v12, 2688, v12
    v_lshl_add_u32 v12, v240, 4, v12
    s_cmp_lt_u32 s2, 224
    s_cselect_b32 s64, 3, 0
    s_cmp_lt_u32 s48, s64
    s_cselect_b32 s64, 1, 0
    s_cselect_b32 s14, s14, 0
    s_cselect_b32 s18, s18, 0
    s_cmp_eq_u32 s48, 2
    s_cselect_b32 s18, 0, s18
    s_mul_i32 s65, s63, 86016
    s_mul_i32 s66, s48, 896
    s_add_u32 s65, s65, s66
    s_mul_i32 s66, s62, 56
    s_add_u32 s65, s65, s66
    buffer_load_dwordx4 v[84:87], v12, s[12:15], s65 offen
    buffer_load_dwordx4 v[88:91], v12, s[12:15], s65 offen offset:32
    s_mul_i32 s65, s62, 1568
    s_lshl_b32 s66, s48, 11
    s_add_u32 m0, s66, 16384
    s_add_u32 s66, s66, 16384
    buffer_load_dwordx4 v1, s[16:19], s65 offen lds
    buffer_load_dwordx4 v1, s[16:19], s65 offen offset:1024 lds
    v_bfe_u32 v13, v0, 2, 2
    v_lshl_add_u32 v13, v240, 3, v13
    v_mul_u32_u24 v116, 56, v13
    v_bfe_u32 v13, v0, 4, 1
    v_lshl_add_u32 v116, v13, 5, v116
    v_and_b32 v13, 3, v0
    v_lshl_add_u32 v116, v13, 3, v116
    v_add_u32 v116, s66, v116
    s_cmp_lt_u32 s50, 25
    s_cbranch_scc1 L_not3
    s_mov_b32 s26, 7340032
    s_mov_b32 s27, 0x20000
    s_cmp_ge_u32 s50, 25
    s_cselect_b32 s69, 0, 0x80000000
    v_mul_u32_u24 v6, 3584, v0
    v_or_b32 v6, s69, v6
    s_max_u32 s68, s67, 100
    s_sub_u32 s68, s68, 100
    s_mul_i32 s68, s68, 265216
    s_lshr_b32 s69, s49, 1
    s_mul_i32 s69, s69, 896
    s_add_u32 s68, s68, s69
    s_add_u32 s68, s68, 384
    buffer_load_dword v254, v6, s[24:27], s68 offen
    s_add_u32 s68, s68, 229376
    s_mov_b64 exec, 0x3ff
    buffer_load_dword v253, v6, s[24:27], s68 offen
    s_mov_b64 exec, -1
L_not3:
    s_mov_b32 s26, 7340032
    s_mov_b32 s27, 0x20000
    s_mov_b32 s46, 268435456
    s_mov_b32 s47, 0x20000
    s_and_b32 s60, s49, 1
    s_sub_u32 s61, 25, s60
    s_cmp_lt_u32 s50, s61
    s_cselect_b32 s54, 1, 0
    s_cselect_b32 s26, s26, 0
    s_mul_i32 s60, s60, 25
    s_lshr_b32 s61, s49, 1
    s_mul_i32 s61, s61, 49
    s_add_u32 s60, s60, s61
    s_add_u32 s60, s60, s50
    s_mul_i32 s52, s60, 9363
    s_lshr_b32 s52, s52, 16
    s_mul_i32 s61, s52, 7
    s_sub_u32 s53, s60, s61
    s_mul_i32 s72, s48, 24576
    s_add_u32 s72, s72, 61440
    v_lshrrev_b32 v8, 3, v0
    v_and_b32 v9, 7, v0
    v_lshrrev_b32 v11, 2, v0
    v_and_b32 v11, 4, v11
    v_xor_b32 v9, v9, v11
    v_lshlrev_b32 v9, 4, v9
    v_mul_u32_u24 v2, 3584, v8
    v_add_u32 v2, v2, v9
    v_add_u32 v3, 27648, v2
    s_mul_i32 s68, s48, 1835008
    s_lshl_b32 s69, s52, 7
    s_add_u32 s68, s68, s69
    s_mul_i32 s4, s53, 5
    s_sub_u32 s4, 32, s4
    s_mul_i32 s1, s53, 286720
    s_add_u32 s1, s1, s68
    s_sub_u32 s3, s1, 1835008
    s_mul_i32 s65, s48, 1824
    v_mul_u32_u24 v11, 912, v240
    v_lshl_add_u32 v11, v241, 4, v11
    v_add_u32 v11, s65, v11
    s_mov_b32 s76, 0x0fffffff
    s_mov_b32 s77, 0x0fffffff
    v_and_b32 v6, 7, v0
    v_mul_u32_u24 v12, 912, v6
    v_lshl_add_u32 v12, v8, 4, v12
    v_lshlrev_b32 v13, 9, v8
    v_lshl_add_u32 v13, v6, 4, v13
    v_bfe_u32 v6, v0, 2, 2
    v_mul_u32_u24 v14, 912, v6
    v_lshrrev_b32 v6, 4, v0
    v_lshl_add_u32 v14, v6, 5, v14
    v_and_b32 v6, 3, v0
    v_lshl_add_u32 v14, v6, 3, v14
    v_lshlrev_b32 v242, 10, v240
    v_lshl_add_u32 v242, v241, 4, v242
    s_lshl_b32 s65, s48, 7
    v_add_u32 v12, s65, v12
    v_add_u32 v14, s65, v14
    s_lshr_b32 s65, s2, 2
    s_mul_i32 s65, s65, 28672
    s_and_b32 s66, s2, 3
    s_lshl_b32 s66, s66, 7
    s_add_u32 s65, s65, s66
    s_lshl_b32 s66, s48, 12
    s_add_u32 s65, s65, s66
    s_add_u32 s65, s65, 1048576
    s_lshr_b32 s66, s2, 1
    s_lshl_b32 s66, s66, 11
    s_and_b32 s67, s2, 1
    s_lshl_b32 s67, s67, 9
    s_add_u32 s66, s66, s67
    s_lshl_b32 s67, s48, 18
    s_add_u32 s66, s66, s67
    s_add_u32 s66, s66, 3145728
    s_mul_i32 s67, s62, 86016
    s_mul_i32 s68, s63, 6144
    s_add_u32 s67, s67, s68
    s_lshl_b32 s68, s48, 10
    s_add_u32 s67, s67, s68
    s_add_u32 s67, s67, 5242880
    v_lshlrev_b32 v120, 3, v240
    v_sub_u32 v120, v241, v120
    v_mov_b32 v121, 100
    v_cndmask_b32 v120, v121, v120, vcc
    v_and_b32 v121, 1, v120
    v_lshlrev_b32 v121, 4, v121
    v_mov_b32 v122, 0x3f80
    v_lshlrev_b32 v121, v121, v122
    v_ashrrev_i32 v120, 1, v120
    v_cmp_eq_u32 vcc, 0, v120
    s_nop 1
    v_cndmask_b32 v108, 0, v121, vcc
    v_cmp_eq_u32 vcc, 1, v120
    s_nop 1
    v_cndmask_b32 v109, 0, v121, vcc
    v_cmp_eq_u32 vcc, 2, v120
    s_nop 1
    v_cndmask_b32 v110, 0, v121, vcc
    v_cmp_eq_u32 vcc, 3, v120
    s_nop 1
    v_cndmask_b32 v111, 0, v121, vcc
    v_cmp_eq_u32 vcc, 8, v120
    s_nop 1
    v_cndmask_b32 v112, 0, v121, vcc
    v_cmp_eq_u32 vcc, 9, v120
    s_nop 1
    v_cndmask_b32 v113, 0, v121, vcc
    v_cmp_eq_u32 vcc, 10, v120
    s_nop 1
    v_cndmask_b32 v114, 0, v121, vcc
    v_cmp_eq_u32 vcc, 11, v120
    s_nop 1
    v_cndmask_b32 v115, 0, v121, vcc
    s_waitcnt vmcnt(5)
    v_lshlrev_b32 v24, 16, v16
    v_and_b32 v25, s0, v16
    v_lshlrev_b32 v26, 16, v17
    v_and_b32 v27, s0, v17
    v_lshlrev_b32 v28, 16, v18
    v_and_b32 v29, s0, v18
    v_lshlrev_b32 v30, 16, v19
    v_and_b32 v31, s0, v19
    v_lshlrev_b32 v32, 16, v20
    v_and_b32 v33, s0, v20
    v_lshlrev_b32 v34, 16, v21
    v_and_b32 v35, s0, v21
    v_lshlrev_b32 v36, 16, v22
    v_and_b32 v37, s0, v22
    v_lshlrev_b32 v38, 16, v23
    v_and_b32 v39, s0, v23
.p2align 3
    v_pk_add_f32 v[56:57], v[24:25], v[26:27]
    v_pk_add_f32 v[58:59], v[28:29], v[30:31]
    v_pk_add_f32 v[60:61], v[32:33], v[34:35]
    v_pk_add_f32 v[62:63], v[36:37], v[38:39]
    v_pk_add_f32 v[56:57], v[56:57], v[58:59]
    v_pk_add_f32 v[60:61], v[60:61], v[62:63]
    v_pk_add_f32 v[56:57], v[56:57], v[60:61]
    v_add_f32 v72, v56, v57
    s_nop 1
    v_add_f32_dpp v72, v72, v72 row_ror:8 row_mask:0xf bank_mask:0xf
    s_nop 1
    v_add_f32_dpp v72, v72, v72 row_ror:4 row_mask:0xf bank_mask:0xf
    s_nop 1
    v_add_f32_dpp v72, v72, v72 row_ror:2 row_mask:0xf bank_mask:0xf
    s_nop 1
    v_add_f32_dpp v72, v72, v72 row_ror:1 row_mask:0xf bank_mask:0xf
    v_mov_b32 v64, v72
    s_nop 1
    v_permlane16_swap_b32 v72, v64
    s_add_u32 m0, s72, 0
    s_cmp_gt_u32 s4, 0
    s_cselect_b32 s75, s1, s3
    buffer_load_dwordx4 v2, s[24:27], s75 offen lds
    buffer_load_dwordx4 v3, s[24:27], s75 offen offset:1024 lds
    v_add_f32 v72, v72, v64
    v_mul_f32 v72, 0x3b124925, v72
.p2align 3
    v_pk_add_f32 v[40:41], v[24:25], v[72:73] op_sel_hi:[1,0] neg_lo:[0,1] neg_hi:[0,1]
    v_pk_add_f32 v[42:43], v[26:27], v[72:73] op_sel_hi:[1,0] neg_lo:[0,1] neg_hi:[0,1]
    v_pk_add_f32 v[44:45], v[28:29], v[72:73] op_sel_hi:[1,0] neg_lo:[0,1] neg_hi:[0,1]
    v_pk_add_f32 v[46:47], v[30:31], v[72:73] op_sel_hi:[1,0] neg_lo:[0,1] neg_hi:[0,1]
    v_pk_add_f32 v[48:49], v[32:33], v[72:73] op_sel_hi:[1,0] neg_lo:[0,1] neg_hi:[0,1]
    v_pk_add_f32 v[50:51], v[34:35], v[72:73] op_sel_hi:[1,0] neg_lo:[0,1] neg_hi:[0,1]
    v_pk_add_f32 v[52:53], v[36:37], v[72:73] op_sel_hi:[1,0] neg_lo:[0,1] neg_hi:[0,1]
    v_pk_add_f32 v[54:55], v[38:39], v[72:73] op_sel_hi:[1,0] neg_lo:[0,1] neg_hi:[0,1]
.p2align 3
    v_pk_mul_f32 v[56:57], v[40:41], v[40:41]
    v_pk_mul_f32 v[58:59], v[42:43], v[42:43]
    v_pk_fma_f32 v[56:57], v[44:45], v[44:45], v[56:57]
    v_pk_fma_f32 v[58:59], v[46:47], v[46:47], v[58:59]
    v_pk_fma_f32 v[56:57], v[48:49], v[48:49], v[56:57]
    v_pk_fma_f32 v[58:59], v[50:51], v[50:51], v[58:59]
    v_pk_fma_f32 v[56:57], v[52:53], v[52:53], v[56:57]
    v_pk_fma_f32 v[58:59], v[54:55], v[54:55], v[58:59]
    v_pk_add_f32 v[56:57], v[56:57], v[58:59]
    v_add_f32 v74, v56, v57
    v_mul_f32 v74, v15, v74
    s_nop 1
    v_add_f32_dpp v74, v74, v74 row_ror:8 row_mask:0xf bank_mask:0xf
    s_nop 1
    v_add_f32_dpp v74, v74, v74 row_ror:4 row_mask:0xf bank_mask:0xf
    s_nop 1
    v_add_f32_dpp v74, v74, v74 row_ror:2 row_mask:0xf bank_mask:0xf
    s_add_u32 m0, s72, 2048
    s_cmp_gt_u32 s4, 1
    s_cselect_b32 s75, s1, s3
    s_add_u32 s75, s75, 57344
    buffer_load_dwordx4 v2, s[24:27], s75 offen lds
    buffer_load_dwordx4 v3, s[24:27], s75 offen offset:1024 lds
    v_add_f32_dpp v74, v74, v74 row_ror:1 row_mask:0xf bank_mask:0xf
    v_mov_b32 v64, v74
    s_nop 1
    v_permlane16_swap_b32 v74, v64
    v_add_f32 v74, v74, v64
    v_mul_f32 v74, 0x3b124925, v74
    v_cvt_pk_bf16_f32 v72, v72, v72
    v_and_b32 v72, s0, v72
    v_cvt_pk_bf16_f32 v74, v74, v74
    v_and_b32 v74, s0, v74
    v_add_f32 v74, 0x3727c5ac, v74
    v_cvt_pk_bf16_f32 v74, v74, v74
    v_and_b32 v74, s0, v74
    v_sqrt_f32 v74, v74
.p2align 3
    v_pk_add_f32 v[40:41], v[24:25], v[72:73] op_sel_hi:[1,0] neg_lo:[0,1] neg_hi:[0,1]
    v_pk_add_f32 v[42:43], v[26:27], v[72:73] op_sel_hi:[1,0] neg_lo:[0,1] neg_hi:[0,1]
    v_pk_add_f32 v[44:45], v[28:29], v[72:73] op_sel_hi:[1,0] neg_lo:[0,1] neg_hi:[0,1]
    v_pk_add_f32 v[46:47], v[30:31], v[72:73] op_sel_hi:[1,0] neg_lo:[0,1] neg_hi:[0,1]
    v_pk_add_f32 v[48:49], v[32:33], v[72:73] op_sel_hi:[1,0] neg_lo:[0,1] neg_hi:[0,1]
    v_pk_add_f32 v[50:51], v[34:35], v[72:73] op_sel_hi:[1,0] neg_lo:[0,1] neg_hi:[0,1]
    v_pk_add_f32 v[52:53], v[36:37], v[72:73] op_sel_hi:[1,0] neg_lo:[0,1] neg_hi:[0,1]
    v_pk_add_f32 v[54:55], v[38:39], v[72:73] op_sel_hi:[1,0] neg_lo:[0,1] neg_hi:[0,1]
    v_cvt_pk_bf16_f32 v74, v74, v74
    v_and_b32 v74, s0, v74
    v_rcp_f32 v74, v74
.p2align 3
    v_cvt_pk_bf16_f32 v16, v40, v41
    v_cvt_pk_bf16_f32 v17, v42, v43
    v_cvt_pk_bf16_f32 v18, v44, v45
    v_cvt_pk_bf16_f32 v19, v46, v47
    v_cvt_pk_bf16_f32 v20, v48, v49
    s_add_u32 m0, s72, 4096
    s_cmp_gt_u32 s4, 2
    s_cselect_b32 s75, s1, s3
    s_add_u32 s75, s75, 114688
    buffer_load_dwordx4 v2, s[24:27], s75 offen lds
    buffer_load_dwordx4 v3, s[24:27], s75 offen offset:1024 lds
    v_cvt_pk_bf16_f32 v21, v50, v51
    v_cvt_pk_bf16_f32 v22, v52, v53
    v_cvt_pk_bf16_f32 v23, v54, v55
    v_lshlrev_b32 v40, 16, v16
    v_and_b32 v41, s0, v16
    v_lshlrev_b32 v42, 16, v17
    v_and_b32 v43, s0, v17
    v_lshlrev_b32 v44, 16, v18
    v_and_b32 v45, s0, v18
    v_lshlrev_b32 v46, 16, v19
    v_and_b32 v47, s0, v19
    v_lshlrev_b32 v48, 16, v20
    v_and_b32 v49, s0, v20
    v_lshlrev_b32 v50, 16, v21
    v_and_b32 v51, s0, v21
    v_lshlrev_b32 v52, 16, v22
    v_and_b32 v53, s0, v22
    v_lshlrev_b32 v54, 16, v23
    v_and_b32 v55, s0, v23
.p2align 3
    v_pk_mul_f32 v[40:41], v[40:41], v[74:75] op_sel_hi:[1,0]
    v_pk_mul_f32 v[42:43], v[42:43], v[74:75] op_sel_hi:[1,0]
    v_pk_mul_f32 v[44:45], v[44:45], v[74:75] op_sel_hi:[1,0]
    v_pk_mul_f32 v[46:47], v[46:47], v[74:75] op_sel_hi:[1,0]
    v_pk_mul_f32 v[48:49], v[48:49], v[74:75] op_sel_hi:[1,0]
    v_pk_mul_f32 v[50:51], v[50:51], v[74:75] op_sel_hi:[1,0]
    v_pk_mul_f32 v[52:53], v[52:53], v[74:75] op_sel_hi:[1,0]
    v_pk_mul_f32 v[54:55], v[54:55], v[74:75] op_sel_hi:[1,0]
.p2align 3
    v_cvt_pk_bf16_f32 v16, v40, v41
    v_cvt_pk_bf16_f32 v17, v42, v43
    v_cvt_pk_bf16_f32 v18, v44, v45
    s_add_u32 m0, s72, 6144
    s_cmp_gt_u32 s4, 3
    s_cselect_b32 s75, s1, s3
    s_add_u32 s75, s75, 172032
    buffer_load_dwordx4 v2, s[24:27], s75 offen lds
    buffer_load_dwordx4 v3, s[24:27], s75 offen offset:1024 lds
    v_cvt_pk_bf16_f32 v19, v46, v47
    v_cvt_pk_bf16_f32 v20, v48, v49
    v_cvt_pk_bf16_f32 v21, v50, v51
    v_cvt_pk_bf16_f32 v22, v52, v53
    v_cvt_pk_bf16_f32 v23, v54, v55
    s_mov_b64 exec, s[76:77]
    ds_write_b128 v11, v[16:19]
    ds_write_b128 v11, v[20:23] offset:448
    s_mov_b64 exec, -1
    s_cmp_eq_u32 s48, 3
    s_cselect_b32 s69, 0x80000000, 0
    v_or_b32 v152, s69, v13
    v_or_b32 v243, s69, v242
    s_mov_b32 s101, s66
    s_waitcnt lgkmcnt(0)
    s_barrier
    ds_read_b128 v[156:159], v12
    ds_read_b128 v[160:163], v12 offset:512
    s_mul_i32 s51, s51, 0x9e3779b1
    s_add_u32 s51, s51, 0x7f4a7c15
    v_lshlrev_b32 v24, 16, v16
    v_and_b32 v25, s0, v16
    v_lshlrev_b32 v26, 16, v17
    v_and_b32 v27, s0, v17
    v_lshlrev_b32 v28, 16, v18
    v_and_b32 v29, s0, v18
    v_lshlrev_b32 v30, 16, v19
    v_and_b32 v31, s0, v19
    v_lshlrev_b32 v32, 16, v20
    v_and_b32 v33, s0, v20
    v_lshlrev_b32 v34, 16, v21
    v_and_b32 v35, s0, v21
    v_lshlrev_b32 v36, 16, v22
    v_and_b32 v37, s0, v22
    v_lshlrev_b32 v38, 16, v23
    v_and_b32 v39, s0, v23
    s_waitcnt lgkmcnt(0)
    buffer_store_dwordx4 v[156:159], v13, s[44:47], s65 offen sc1
    s_add_u32 s65, s65, 16384
    buffer_store_dwordx4 v[160:163], v152, s[44:47], s65 offen sc1
.p2align 3
    v_pk_add_f32 v[56:57], v[24:25], v[26:27]
    v_pk_add_f32 v[58:59], v[28:29], v[30:31]
    v_pk_add_f32 v[60:61], v[32:33], v[34:35]
    v_pk_add_f32 v[62:63], v[36:37], v[38:39]
    v_pk_add_f32 v[56:57], v[56:57], v[58:59]
    v_pk_add_f32 v[60:61], v[60:61], v[62:63]
    v_pk_add_f32 v[56:57], v[56:57], v[60:61]
    s_add_u32 m0, s72, 8192
    s_cmp_gt_u32 s4, 4
    s_cselect_b32 s75, s1, s3
    s_add_u32 s75, s75, 229376
    buffer_load_dwordx4 v2, s[24:27], s75 offen lds
    buffer_load_dwordx4 v3, s[24:27], s75 offen offset:1024 lds
    v_add_f32 v72, v56, v57
.p2align 3
    v_pk_mul_f32 v[64:65], v[24:25], v[24:25]
    v_pk_mul_f32 v[66:67], v[26:27], v[26:27]
    v_pk_fma_f32 v[64:65], v[28:29], v[28:29], v[64:65]
    v_pk_fma_f32 v[66:67], v[30:31], v[30:31], v[66:67]
    v_pk_fma_f32 v[64:65], v[32:33], v[32:33], v[64:65]
    v_pk_fma_f32 v[66:67], v[34:35], v[34:35], v[66:67]
    v_pk_fma_f32 v[64:65], v[36:37], v[36:37], v[64:65]
    v_pk_fma_f32 v[66:67], v[38:39], v[38:39], v[66:67]
    v_pk_add_f32 v[64:65], v[64:65], v[66:67]
    v_add_f32 v74, v64, v65
    v_mul_f32 v72, v15, v72
    v_mul_f32 v74, v15, v74
    s_nop 0
    v_add_f32_dpp v72, v72, v72 row_ror:8 row_mask:0xf bank_mask:0xf
    v_add_f32_dpp v74, v74, v74 row_ror:8 row_mask:0xf bank_mask:0xf
    s_nop 0
    v_add_f32_dpp v72, v72, v72 row_ror:4 row_mask:0xf bank_mask:0xf
    v_add_f32_dpp v74, v74, v74 row_ror:4 row_mask:0xf bank_mask:0xf
    s_nop 0
    v_add_f32_dpp v72, v72, v72 row_ror:2 row_mask:0xf bank_mask:0xf
    v_add_f32_dpp v74, v74, v74 row_ror:2 row_mask:0xf bank_mask:0xf
    s_nop 0
    v_add_f32_dpp v72, v72, v72 row_ror:1 row_mask:0xf bank_mask:0xf
    v_add_f32_dpp v74, v74, v74 row_ror:1 row_mask:0xf bank_mask:0xf
    v_mov_b32 v56, v72
    v_mov_b32 v57, v74
    s_nop 0
    v_permlane16_swap_b32 v72, v56
    v_permlane16_swap_b32 v74, v57
    v_add_f32 v72, v72, v56
    v_add_f32 v74, v74, v57
    v_mul_f32 v72, 0x3b124925, v72
    v_mul_f32 v74, 0x3b124925, v74
    v_fma_f32 v74, -v72, v72, v74
    v_max_f32 v74, 0, v74
    v_cvt_pk_bf16_f32 v72, v72, v72
    v_and_b32 v72, s0, v72
    v_cvt_pk_bf16_f32 v74, v74, v74
    v_and_b32 v74, s0, v74
    v_add_f32 v74, 0x3727c5ac, v74
    v_cvt_pk_bf16_f32 v74, v74, v74
    v_and_b32 v74, s0, v74
    v_sqrt_f32 v74, v74
.p2align 3
    v_pk_add_f32 v[40:41], v[24:25], v[72:73] op_sel_hi:[1,0] neg_lo:[0,1] neg_hi:[0,1]
    v_pk_add_f32 v[42:43], v[26:27], v[72:73] op_sel_hi:[1,0] neg_lo:[0,1] neg_hi:[0,1]
    v_pk_add_f32 v[44:45], v[28:29], v[72:73] op_sel_hi:[1,0] neg_lo:[0,1] neg_hi:[0,1]
    v_pk_add_f32 v[46:47], v[30:31], v[72:73] op_sel_hi:[1,0] neg_lo:[0,1] neg_hi:[0,1]
    v_pk_add_f32 v[48:49], v[32:33], v[72:73] op_sel_hi:[1,0] neg_lo:[0,1] neg_hi:[0,1]
    v_pk_add_f32 v[50:51], v[34:35], v[72:73] op_sel_hi:[1,0] neg_lo:[0,1] neg_hi:[0,1]
    v_pk_add_f32 v[52:53], v[36:37], v[72:73] op_sel_hi:[1,0] neg_lo:[0,1] neg_hi:[0,1]
    v_pk_add_f32 v[54:55], v[38:39], v[72:73] op_sel_hi:[1,0] neg_lo:[0,1] neg_hi:[0,1]
    v_cvt_pk_bf16_f32 v74, v74, v74
    v_and_b32 v74, s0, v74
    v_rcp_f32 v74, v74
.p2align 3
    v_cvt_pk_bf16_f32 v76, v40, v41
    v_cvt_pk_bf16_f32 v77, v42, v43
    v_cvt_pk_bf16_f32 v78, v44, v45
    v_cvt_pk_bf16_f32 v79, v46, v47
    v_cvt_pk_bf16_f32 v80, v48, v49
    v_cvt_pk_bf16_f32 v81, v50, v51
    v_cvt_pk_bf16_f32 v82, v52, v53
    v_cvt_pk_bf16_f32 v83, v54, v55
    v_lshlrev_b32 v40, 16, v76
    v_and_b32 v41, s0, v76
    v_lshlrev_b32 v42, 16, v77
    v_and_b32 v43, s0, v77
    v_lshlrev_b32 v44, 16, v78
    v_and_b32 v45, s0, v78
    v_lshlrev_b32 v46, 16, v79
    v_and_b32 v47, s0, v79
    v_lshlrev_b32 v48, 16, v80
    v_and_b32 v49, s0, v80
    v_lshlrev_b32 v50, 16, v81
    v_and_b32 v51, s0, v81
    v_lshlrev_b32 v52, 16, v82
    v_and_b32 v53, s0, v82
    v_lshlrev_b32 v54, 16, v83
    v_and_b32 v55, s0, v83
.p2align 3
    v_pk_mul_f32 v[40:41], v[40:41], v[74:75] op_sel_hi:[1,0]
    v_pk_mul_f32 v[42:43], v[42:43], v[74:75] op_sel_hi:[1,0]
    v_pk_mul_f32 v[44:45], v[44:45], v[74:75] op_sel_hi:[1,0]
    v_pk_mul_f32 v[46:47], v[46:47], v[74:75] op_sel_hi:[1,0]
    v_pk_mul_f32 v[48:49], v[48:49], v[74:75] op_sel_hi:[1,0]
    v_pk_mul_f32 v[50:51], v[50:51], v[74:75] op_sel_hi:[1,0]
    v_pk_mul_f32 v[52:53], v[52:53], v[74:75] op_sel_hi:[1,0]
    v_pk_mul_f32 v[54:55], v[54:55], v[74:75] op_sel_hi:[1,0]
.p2align 3
    v_cvt_pk_bf16_f32 v76, v40, v41
    v_cvt_pk_bf16_f32 v77, v42, v43
    v_cvt_pk_bf16_f32 v78, v44, v45
    v_cvt_pk_bf16_f32 v79, v46, v47
    v_cvt_pk_bf16_f32 v80, v48, v49
    v_cvt_pk_bf16_f32 v81, v50, v51
    v_cvt_pk_bf16_f32 v82, v52, v53
    v_cvt_pk_bf16_f32 v83, v54, v55
    s_mov_b64 exec, s[76:77]
    ds_write_b128 v11, v[76:79] offset:7296
    ds_write_b128 v11, v[80:83] offset:7744
    s_mov_b64 exec, -1
    s_cmp_eq_u32 s64, 0
    s_cbranch_scc1 L_nounit1
    s_waitcnt vmcnt(12)
    s_cmp_eq_u32 s48, 2
    s_cbranch_scc1 L_unitmm
    ds_read_b64_tr_b16 v[108:109], v116 offset:0
    ds_read_b64_tr_b16 v[110:111], v116 offset:224
    ds_read_b64_tr_b16 v[112:113], v116 offset:896
    ds_read_b64_tr_b16 v[114:115], v116 offset:1120
    s_mov_b32 vcc_lo, 0x33ffffff
    s_mov_b32 vcc_hi, 0x33ffffff
    s_mov_b32 s98, 0x33ffffff
    s_mov_b32 s99, 0
    s_waitcnt lgkmcnt(0)
    v_mov_b32_dpp v108, v108 row_shr:2 row_mask:0xa bank_mask:0x8
    v_mov_b32_dpp v109, v109 row_shr:2 row_mask:0xa bank_mask:0x8
    v_mov_b32_dpp v110, v110 row_shr:2 row_mask:0xa bank_mask:0x8
    v_mov_b32_dpp v111, v111 row_shr:2 row_mask:0xa bank_mask:0x8
    v_mov_b32_dpp v112, v112 row_shr:2 row_mask:0xa bank_mask:0x8
    v_mov_b32_dpp v113, v113 row_shr:2 row_mask:0xa bank_mask:0x8
    v_mov_b32_dpp v114, v114 row_shr:2 row_mask:0xa bank_mask:0x8
    v_mov_b32_dpp v115, v115 row_shr:2 row_mask:0xa bank_mask:0x8
    v_cndmask_b32 v108, 0, v108, vcc
    v_cndmask_b32 v109, 0, v109, vcc
    v_cndmask_b32 v110, 0, v110, vcc
    v_cndmask_b32 v111, 0, v111, vcc
    v_cndmask_b32 v112, 0, v112, vcc
    v_cndmask_b32 v113, 0, v113, vcc
    v_cndmask_b32 v114, 0, v114, s[98:99]
    v_cndmask_b32 v115, 0, v115, s[98:99]
L_unitmm:
    v_mfma_f32_32x32x16_bf16 v[128:143], v[84:87], v[108:111], 0
    s_nop 0
    v_mfma_f32_32x32x16_bf16 v[128:143], v[88:91], v[112:115], v[128:143]
.p2align 3
    s_nop 11
    v_cvt_pk_bf16_f32 v144, v128, v129
    v_cvt_pk_bf16_f32 v145, v130, v131
    v_cvt_pk_bf16_f32 v146, v132, v133
    v_cvt_pk_bf16_f32 v147, v134, v135
    v_cvt_pk_bf16_f32 v148, v136, v137
    v_cvt_pk_bf16_f32 v149, v138, v139
    v_cvt_pk_bf16_f32 v150, v140, v141
    v_cvt_pk_bf16_f32 v151, v142, v143
    buffer_store_dwordx4 v[144:147], v1, s[44:47], s67 offen sc1
    buffer_store_dwordx4 v[148:151], v1, s[44:47], s67 offen offset:3072 sc1
L_nounit1:
    s_waitcnt lgkmcnt(0)
    s_barrier
    ds_read_b64_tr_b16 v[224:225], v14 offset:7296
    ds_read_b64_tr_b16 v[226:227], v14 offset:10944
    ds_read_b64_tr_b16 v[228:229], v14 offset:7808
    ds_read_b64_tr_b16 v[230:231], v14 offset:11456
    s_add_u32 m0, s72, 10240
    s_cmp_gt_u32 s4, 5
    s_cselect_b32 s75, s1, s3
    s_add_u32 s75, s75, 286720
    buffer_load_dwordx4 v2, s[24:27], s75 offen lds
    buffer_load_dwordx4 v3, s[24:27], s75 offen offset:1024 lds
    s_add_u32 m0, s72, 12288
    s_cmp_gt_u32 s4, 6
    s_cselect_b32 s75, s1, s3
    s_add_u32 s75, s75, 344064
    buffer_load_dwordx4 v2, s[24:27], s75 offen lds
    buffer_load_dwordx4 v3, s[24:27], s75 offen offset:1024 lds
    s_mov_b32 s22, 401408
    s_mov_b32 s23, 0x20000
    s_mov_b32 s30, 3584
    s_mov_b32 s31, 0x20000
    s_mov_b32 s34, 7340032
    s_mov_b32 s35, 0x20000
    s_mov_b32 s38, 4096
    s_mov_b32 s39, 0x20000
    s_mov_b32 s42, 1835008
    s_mov_b32 s43, 0x20000
    s_and_b32 s60, s49, 1
    s_lshl_b32 s60, s60, 3
    s_and_b32 s61, s50, 7
    s_add_u32 s55, s60, s61
    s_lshr_b32 s60, s49, 1
    s_lshl_b32 s60, s60, 2
    s_lshr_b32 s61, s50, 3
    s_add_u32 s56, s60, s61
    s_cmp_lt_u32 s50, 28
    s_cselect_b32 s59, 1, 0
    s_mul_i32 s60, s50, 37
    s_lshr_b32 s60, s60, 8
    s_mul_i32 s61, s60, 7
    s_sub_u32 s58, s50, s61
    s_lshl_b32 s57, s49, 2
    s_add_u32 s57, s57, s60
    v_bfe_u32 v11, v0, 2, 2
    v_lshlrev_b32 v10, 7, v11
    v_lshrrev_b32 v11, 1, v11
    v_lshl_add_u32 v10, v11, 6, v10
    v_bfe_u32 v11, v0, 4, 1
    v_lshl_add_u32 v10, v11, 5, v10
    v_and_b32 v11, 3, v0
    v_lshl_add_u32 v10, v11, 3, v10
    v_add_u32 v10, s72, v10
    v_lshl_add_u32 v4, v240, 10, v10
    s_lshr_b32 s69, s48, 1
    s_and_b32 s69, s69, 1
    s_lshl_b32 s69, s69, 6
    v_xor_b32 v4, s69, v4
    v_xor_b32 v5, 64, v4
    s_lshr_b32 s65, s2, 2
    s_lshl_b32 s65, s65, 7
    s_and_b32 s67, s2, 3
    s_lshl_b32 s67, s67, 2
    s_add_u32 s65, s65, s67
    s_cmp_lg_u32 s48, 0
    s_cselect_b32 s66, 0x80000000, 0
    s_lshl_b32 s60, s56, 4
    v_min_u32 v12, 29, v0
    v_add_u32 v13, s60, v12
    v_and_b32 v12, 15, v12
    v_lshl_add_u32 v12, v12, 4, s55
    v_mul_u32_u24 v14, 2341, v12
    v_lshrrev_b32 v14, 16, v14
    v_mul_u32_u24 v15, 28, v14
    v_sub_u32 v12, v12, v15
    v_lshl_add_u32 v12, v12, 3, v14
    v_cmp_gt_u32 vcc, 16, v0
    s_nop 1
    v_cndmask_b32 v12, v12, v13, vcc
    v_and_b32 v13, 3, v12
    v_lshrrev_b32 v12, 2, v12
    v_lshlrev_b32 v13, 2, v13
    v_lshl_add_u32 v12, v12, 7, v13
    v_or_b32 v247, s66, v12
    s_mov_b32 s96, s65
    s_cmp_eq_u32 s54, 0
    s_cbranch_scc1 L_w1skip
    s_add_u32 m0, s72, 14336
    s_cmp_gt_u32 s4, 7
    s_cselect_b32 s75, s1, s3
    s_add_u32 s75, s75, 401408
    buffer_load_dwordx4 v2, s[24:27], s75 offen lds
    buffer_load_dwordx4 v3, s[24:27], s75 offen offset:1024 lds
    s_add_u32 m0, s72, 16384
    s_cmp_gt_u32 s4, 8
    s_cselect_b32 s75, s1, s3
    s_add_u32 s75, s75, 458752
    buffer_load_dwordx4 v2, s[24:27], s75 offen lds
    buffer_load_dwordx4 v3, s[24:27], s75 offen offset:1024 lds
    s_add_u32 m0, s72, 18432
    s_cmp_gt_u32 s4, 9
    s_cselect_b32 s75, s1, s3
    s_add_u32 s75, s75, 516096
    buffer_load_dwordx4 v2, s[24:27], s75 offen lds
    s_waitcnt vmcnt(19)
    ds_read_b64_tr_b16 a[0:1], v4 offset:0
    ds_read_b64_tr_b16 a[2:3], v4 offset:512
    buffer_load_dwordx4 v3, s[24:27], s75 offen offset:1024 lds
    ds_read_b64_tr_b16 a[4:5], v5 offset:0
    ds_read_b64_tr_b16 a[6:7], v5 offset:512
    s_add_u32 m0, s72, 20480
    s_cmp_gt_u32 s4, 10
    s_cselect_b32 s75, s1, s3
    s_add_u32 s75, s75, 573440
    buffer_load_dwordx4 v2, s[24:27], s75 offen lds
    s_waitcnt vmcnt(19)
    ds_read_b64_tr_b16 a[8:9], v4 offset:2048
    ds_read_b64_tr_b16 a[10:11], v4 offset:2560
    buffer_load_dwordx4 v3, s[24:27], s75 offen offset:1024 lds
    ds_read_b64_tr_b16 a[12:13], v5 offset:2048
    ds_read_b64_tr_b16 a[14:15], v5 offset:2560
    s_add_u32 m0, s72, 22528
    s_cmp_gt_u32 s4, 11
    s_cselect_b32 s75, s1, s3
    s_add_u32 s75, s75, 630784
    buffer_load_dwordx4 v2, s[24:27], s75 offen lds
    s_waitcnt vmcnt(19)
    ds_read_b64_tr_b16 a[16:17], v4 offset:4096
    ds_read_b64_tr_b16 a[18:19], v4 offset:4608
    buffer_load_dwordx4 v3, s[24:27], s75 offen offset:1024 lds
    ds_read_b64_tr_b16 a[20:21], v5 offset:4096
    ds_read_b64_tr_b16 a[22:23], v5 offset:4608
    s_waitcnt vmcnt(14)
    s_barrier
    s_cmp_lg_u32 s48, 3
    s_cbranch_scc1 L_wf_1
    v_mov_b32 v249, s51
    v_mov_b32 v248, 0
    s_mov_b64 exec, 1
    buffer_store_dword v249, v248, s[44:47], s96 offen sc1
    s_mov_b64 exec, -1
L_wf_1:
    s_waitcnt lgkmcnt(8)
    s_add_u32 m0, s72, 0
    s_cmp_gt_u32 s4, 12
    s_cselect_b32 s75, s1, s3
    s_add_u32 s75, s75, 688128
    buffer_load_dwordx4 v2, s[24:27], s75 offen lds
    ds_read_b64_tr_b16 a[24:25], v4 offset:6144
    ds_read_b64_tr_b16 a[26:27], v4 offset:6656
    buffer_load_dwordx4 v3, s[24:27], s75 offen offset:1024 lds
    ds_read_b64_tr_b16 a[28:29], v5 offset:6144
    ds_read_b64_tr_b16 a[30:31], v5 offset:6656
    v_lshrrev_b32 v245, 2, v0
    v_and_b32 v246, 3, v0
    v_lshlrev_b32 v246, 2, v246
    s_waitcnt lgkmcnt(8)
    s_add_u32 m0, s72, 2048
    s_cmp_gt_u32 s4, 13
    s_cselect_b32 s75, s1, s3
    s_add_u32 s75, s75, 745472
    buffer_load_dwordx4 v2, s[24:27], s75 offen lds
    ds_read_b64_tr_b16 a[32:33], v4 offset:8192
    ds_read_b64_tr_b16 a[34:35], v4 offset:8704
    v_lshl_add_u32 v245, v245, 7, v246
    s_lshr_b32 s69, s48, 0
    s_and_b32 s69, s69, 1
    buffer_load_dwordx4 v3, s[24:27], s75 offen offset:1024 lds
    ds_read_b64_tr_b16 a[36:37], v5 offset:8192
    ds_read_b64_tr_b16 a[38:39], v5 offset:8704
    s_lshl_b32 s69, s69, 10
    v_add_u32 v6, s69, v1
    v_xor_b32 v7, 0x400, v6
    s_waitcnt lgkmcnt(8)
    s_add_u32 m0, s72, 4096
    s_cmp_gt_u32 s4, 14
    s_cselect_b32 s75, s1, s3
    s_add_u32 s75, s75, 802816
    buffer_load_dwordx4 v2, s[24:27], s75 offen lds
    s_waitcnt vmcnt(17)
    ds_read_b64_tr_b16 a[40:41], v4 offset:10240
    ds_read_b64_tr_b16 a[42:43], v4 offset:10752
    s_lshl_b32 s68, s53, 7
    s_lshl_b32 s69, s48, 5
    s_add_u32 s68, s68, s69
    buffer_load_dwordx4 v3, s[24:27], s75 offen offset:1024 lds
    ds_read_b64_tr_b16 a[44:45], v5 offset:10240
    ds_read_b64_tr_b16 a[46:47], v5 offset:10752
    s_lshl_b32 s68, s68, 11
    s_add_u32 s68, s68, 3145728
    s_mul_i32 s73, s53, 5
    s_waitcnt lgkmcnt(8)
    s_add_u32 m0, s72, 6144
    s_cmp_gt_u32 s4, 15
    s_cselect_b32 s75, s1, s3
    s_add_u32 s75, s75, 860160
    buffer_load_dwordx4 v2, s[24:27], s75 offen lds
    s_waitcnt vmcnt(17)
    ds_read_b64_tr_b16 a[48:49], v4 offset:12288
    ds_read_b64_tr_b16 a[50:51], v4 offset:12800
    s_sub_u32 s73, 32, s73
    s_mul_i32 s5, s53, 10240
    s_add_u32 s5, s5, s68
    buffer_load_dwordx4 v3, s[24:27], s75 offen offset:1024 lds
    ds_read_b64_tr_b16 a[52:53], v5 offset:12288
    ds_read_b64_tr_b16 a[54:55], v5 offset:12800
    s_sub_u32 s6, s5, 65536
    v_and_b32 v11, 1, v241
    v_xor_b32 v11, v11, v240
    s_waitcnt lgkmcnt(8)
    s_add_u32 m0, s72, 8192
    s_cmp_gt_u32 s4, 16
    s_cselect_b32 s75, s1, s3
    s_add_u32 s75, s75, 917504
    buffer_load_dwordx4 v2, s[24:27], s75 offen lds
    s_waitcnt vmcnt(17)
    ds_read_b64_tr_b16 a[56:57], v4 offset:14336
    ds_read_b64_tr_b16 a[58:59], v4 offset:14848
    v_bfe_u32 v12, v241, 2, 2
    v_lshl_or_b32 v11, v12, 1, v11
    v_and_b32 v12, 2, v241
    buffer_load_dwordx4 v3, s[24:27], s75 offen offset:1024 lds
    ds_read_b64_tr_b16 a[60:61], v5 offset:14336
    ds_read_b64_tr_b16 a[62:63], v5 offset:14848
    v_lshl_or_b32 v11, v12, 2, v11
    v_lshlrev_b32 v11, 3, v11
    v_lshl_or_b32 v11, v241, 7, v11
    s_waitcnt lgkmcnt(8)
    s_add_u32 m0, s72, 10240
    s_cmp_gt_u32 s4, 17
    s_cselect_b32 s75, s1, s3
    s_add_u32 s75, s75, 974848
    buffer_load_dwordx4 v2, s[24:27], s75 offen lds
    s_waitcnt vmcnt(17)
    ds_read_b64_tr_b16 a[64:65], v4 offset:16384
    ds_read_b64_tr_b16 a[66:67], v4 offset:16896
    s_lshl_b32 s65, s48, 12
    s_add_u32 s65, s65, 24576
    v_add_u32 v11, s65, v11
    buffer_load_dwordx4 v3, s[24:27], s75 offen offset:1024 lds
    ds_read_b64_tr_b16 a[68:69], v5 offset:16384
    ds_read_b64_tr_b16 a[70:71], v5 offset:16896
    v_subrev_u32 v12, s72, v10
    v_lshl_add_u32 v12, v240, 9, v12
    s_and_b32 s65, s48, 1
    buffer_store_dwordx4 v[224:227], v242, s[44:47], s101 offen sc1
    s_add_u32 s101, s101, 1048576
    buffer_store_dwordx4 v[228:231], v243, s[44:47], s101 offen sc1
    s_waitcnt lgkmcnt(8)
    s_add_u32 m0, s72, 12288
    s_cmp_gt_u32 s4, 18
    s_cselect_b32 s75, s1, s3
    s_add_u32 s75, s75, 1032192
    buffer_load_dwordx4 v2, s[24:27], s75 offen lds
    s_waitcnt vmcnt(19)
    ds_read_b64_tr_b16 a[72:73], v4 offset:18432
    ds_read_b64_tr_b16 a[74:75], v4 offset:18944
    s_lshl_b32 s65, s65, 6
    s_lshr_b32 s66, s48, 1
    s_lshl_b32 s66, s66, 5
    buffer_load_dwordx4 v3, s[24:27], s75 offen offset:1024 lds
    ds_read_b64_tr_b16 a[76:77], v5 offset:18432
    ds_read_b64_tr_b16 a[78:79], v5 offset:18944
    s_or_b32 s65, s65, s66
    v_xor_b32 v12, s65, v12
    v_bfe_u32 v13, v0, 2, 1
    s_waitcnt lgkmcnt(8)
    s_add_u32 m0, s72, 14336
    s_cmp_gt_u32 s4, 19
    s_cselect_b32 s75, s1, s3
    s_add_u32 s75, s75, 1089536
    buffer_load_dwordx4 v2, s[24:27], s75 offen lds
    s_waitcnt vmcnt(19)
    ds_read_b64_tr_b16 a[80:81], v4 offset:20480
    ds_read_b64_tr_b16 a[82:83], v4 offset:20992
    v_lshlrev_b32 v13, 3, v13
    v_lshl_or_b32 v13, v240, 4, v13
    v_xor_b32 v12, v12, v13
    buffer_load_dwordx4 v3, s[24:27], s75 offen offset:1024 lds
    ds_read_b64_tr_b16 a[84:85], v5 offset:20480
    ds_read_b64_tr_b16 a[86:87], v5 offset:20992
    v_add_u32 v12, 24576, v12
    v_xor_b32 v13, 32, v12
    s_lshl_b32 s65, s48, 11
    s_waitcnt lgkmcnt(8)
    s_add_u32 m0, s72, 16384
    s_cmp_gt_u32 s4, 20
    s_cselect_b32 s75, s1, s3
    s_add_u32 s75, s75, 1146880
    buffer_load_dwordx4 v2, s[24:27], s75 offen lds
    s_waitcnt vmcnt(19)
    ds_read_b64_tr_b16 a[88:89], v4 offset:22528
    ds_read_b64_tr_b16 a[90:91], v4 offset:23040
    s_add_u32 s65, s65, 40960
    v_add_u32 v14, s65, v1
    v_add_u32 v15, 40960, v1
    buffer_load_dwordx4 v3, s[24:27], s75 offen offset:1024 lds
    ds_read_b64_tr_b16 a[92:93], v5 offset:22528
    ds_read_b64_tr_b16 a[94:95], v5 offset:23040
    s_lshl_b32 s64, s55, 4
    s_add_u32 s64, s64, s56
    s_lshl_b32 s65, s64, 13
    s_waitcnt lgkmcnt(8)
    s_add_u32 m0, s72, 18432
    s_cmp_gt_u32 s4, 21
    s_cselect_b32 s75, s1, s3
    s_add_u32 s75, s75, 1204224
    buffer_load_dwordx4 v2, s[24:27], s75 offen lds
    s_waitcnt vmcnt(19)
    ds_read_b64_tr_b16 a[96:97], v4 offset:0
    ds_read_b64_tr_b16 a[98:99], v4 offset:512
    s_and_b32 s66, s48, 1
    s_lshl_b32 s66, s66, 12
    s_add_u32 s65, s65, s66
    buffer_load_dwordx4 v3, s[24:27], s75 offen offset:1024 lds
    ds_read_b64_tr_b16 a[100:101], v5 offset:0
    ds_read_b64_tr_b16 a[102:103], v5 offset:512
    s_lshr_b32 s66, s48, 1
    s_lshl_b32 s66, s66, 11
    s_add_u32 s65, s65, s66
    s_waitcnt lgkmcnt(8)
    s_add_u32 m0, s72, 20480
    s_cmp_gt_u32 s4, 22
    s_cselect_b32 s75, s1, s3
    s_add_u32 s75, s75, 1261568
    buffer_load_dwordx4 v2, s[24:27], s75 offen lds
    s_waitcnt vmcnt(19)
    ds_read_b64_tr_b16 a[104:105], v4 offset:2048
    ds_read_b64_tr_b16 a[106:107], v4 offset:2560
    s_add_u32 s65, s65, 11534336
    s_lshl_b32 s64, s64, 7
    s_add_u32 s64, s64, 262144
    buffer_load_dwordx4 v3, s[24:27], s75 offen offset:1024 lds
    ds_read_b64_tr_b16 a[108:109], v5 offset:2048
    ds_read_b64_tr_b16 a[110:111], v5 offset:2560
    s_mov_b32 s98, 0x10000000
    s_mov_b32 s99, 0x10000000
    v_cndmask_b32 v80, 0, 1.0, s[98:99]
    s_waitcnt lgkmcnt(8)
    s_add_u32 m0, s72, 22528
    s_cmp_gt_u32 s4, 23
    s_cselect_b32 s75, s1, s3
    s_add_u32 s75, s75, 1318912
    buffer_load_dwordx4 v2, s[24:27], s75 offen lds
    s_waitcnt vmcnt(19)
    ds_read_b64_tr_b16 a[112:113], v4 offset:4096
    ds_read_b64_tr_b16 a[114:115], v4 offset:4608
    v_cndmask_b32 v81, 0, 1.0, s[98:99]
    v_cndmask_b32 v82, 0, 1.0, s[98:99]
    v_cndmask_b32 v83, 0, 1.0, s[98:99]
    buffer_load_dwordx4 v3, s[24:27], s75 offen offset:1024 lds
    ds_read_b64_tr_b16 a[116:117], v5 offset:4096
    ds_read_b64_tr_b16 a[118:119], v5 offset:4608
    v_cndmask_b32 v84, 0, 1.0, s[98:99]
    v_cndmask_b32 v85, 0, 1.0, s[98:99]
    v_cndmask_b32 v86, 0, 1.0, s[98:99]
    s_waitcnt lgkmcnt(8)
    s_add_u32 m0, s72, 0
    s_cmp_gt_u32 s4, 24
    s_cselect_b32 s75, s1, s3
    s_add_u32 s75, s75, 1376256
    buffer_load_dwordx4 v2, s[24:27], s75 offen lds
    s_waitcnt vmcnt(19)
    ds_read_b64_tr_b16 a[120:121], v4 offset:6144
    ds_read_b64_tr_b16 a[122:123], v4 offset:6656
    v_cndmask_b32 v87, 0, 1.0, s[98:99]
    v_cndmask_b32 v88, 0, 1.0, s[98:99]
    v_cndmask_b32 v89, 0, 1.0, s[98:99]
    buffer_load_dwordx4 v3, s[24:27], s75 offen offset:1024 lds
    ds_read_b64_tr_b16 a[124:125], v5 offset:6144
    ds_read_b64_tr_b16 a[126:127], v5 offset:6656
    v_cndmask_b32 v90, 0, 1.0, s[98:99]
    v_cndmask_b32 v91, 0, 1.0, s[98:99]
    v_cndmask_b32 v92, 0, 1.0, s[98:99]
    s_waitcnt lgkmcnt(8)
    s_add_u32 m0, s72, 2048
    s_cmp_gt_u32 s4, 25
    s_cselect_b32 s75, s1, s3
    s_add_u32 s75, s75, 1433600
    buffer_load_dwordx4 v2, s[24:27], s75 offen lds
    s_waitcnt vmcnt(19)
    ds_read_b64_tr_b16 a[128:129], v4 offset:8192
    ds_read_b64_tr_b16 a[130:131], v4 offset:8704
    v_cndmask_b32 v93, 0, 1.0, s[98:99]
    v_cndmask_b32 v94, 0, 1.0, s[98:99]
    v_cndmask_b32 v95, 0, 1.0, s[98:99]
    buffer_load_dwordx4 v3, s[24:27], s75 offen offset:1024 lds
    ds_read_b64_tr_b16 a[132:133], v5 offset:8192
    ds_read_b64_tr_b16 a[134:135], v5 offset:8704
    s_waitcnt lgkmcnt(8)
    s_add_u32 m0, s72, 4096
    s_cmp_gt_u32 s4, 26
    s_cselect_b32 s75, s1, s3
    s_add_u32 s75, s75, 1490944
    buffer_load_dwordx4 v2, s[24:27], s75 offen lds
    s_waitcnt vmcnt(19)
    ds_read_b64_tr_b16 a[136:137], v4 offset:10240
    ds_read_b64_tr_b16 a[138:139], v4 offset:10752
    buffer_load_dwordx4 v3, s[24:27], s75 offen offset:1024 lds
    ds_read_b64_tr_b16 a[140:141], v5 offset:10240
    ds_read_b64_tr_b16 a[142:143], v5 offset:10752
    buffer_load_dword v250, v247, s[44:47], 0 offen sc1
    s_waitcnt lgkmcnt(8)
    s_add_u32 m0, s72, 6144
    s_cmp_gt_u32 s4, 27
    s_cselect_b32 s75, s1, s3
    s_add_u32 s75, s75, 1548288
    buffer_load_dwordx4 v2, s[24:27], s75 offen lds
    s_waitcnt vmcnt(18)
    ds_read_b64_tr_b16 a[144:145], v4 offset:12288
    ds_read_b64_tr_b16 a[146:147], v4 offset:12800
    buffer_load_dwordx4 v3, s[24:27], s75 offen offset:1024 lds
    ds_read_b64_tr_b16 a[148:149], v5 offset:12288
    ds_read_b64_tr_b16 a[150:151], v5 offset:12800
    s_waitcnt lgkmcnt(8)
    s_add_u32 m0, s72, 8192
    s_cmp_gt_u32 s4, 28
    s_cselect_b32 s75, s1, s3
    s_add_u32 s75, s75, 1605632
    buffer_load_dwordx4 v2, s[24:27], s75 offen lds
    s_waitcnt vmcnt(18)
    ds_read_b64_tr_b16 a[152:153], v4 offset:14336
    ds_read_b64_tr_b16 a[154:155], v4 offset:14848
    buffer_load_dwordx4 v3, s[24:27], s75 offen offset:1024 lds
    ds_read_b64_tr_b16 a[156:157], v5 offset:14336
    ds_read_b64_tr_b16 a[158:159], v5 offset:14848
    s_waitcnt lgkmcnt(8)
    s_add_u32 m0, s72, 10240
    s_cmp_gt_u32 s4, 29
    s_cselect_b32 s75, s1, s3
    s_add_u32 s75, s75, 1662976
    buffer_load_dwordx4 v2, s[24:27], s75 offen lds
    s_waitcnt vmcnt(18)
    ds_read_b64_tr_b16 a[160:161], v4 offset:16384
    ds_read_b64_tr_b16 a[162:163], v4 offset:16896
    buffer_load_dwordx4 v3, s[24:27], s75 offen offset:1024 lds
    ds_read_b64_tr_b16 a[164:165], v5 offset:16384
    ds_read_b64_tr_b16 a[166:167], v5 offset:16896
    s_waitcnt lgkmcnt(8)
    s_add_u32 m0, s72, 12288
    s_cmp_gt_u32 s4, 30
    s_cselect_b32 s75, s1, s3
    s_add_u32 s75, s75, 1720320
    buffer_load_dwordx4 v2, s[24:27], s75 offen lds
    s_waitcnt vmcnt(18)
    ds_read_b64_tr_b16 a[168:169], v4 offset:18432
    ds_read_b64_tr_b16 a[170:171], v4 offset:18944
    buffer_load_dwordx4 v3, s[24:27], s75 offen offset:1024 lds
    ds_read_b64_tr_b16 a[172:173], v5 offset:18432
    ds_read_b64_tr_b16 a[174:175], v5 offset:18944
    s_add_u32 s96, s96, 8192
    s_barrier
    s_cmp_lg_u32 s48, 3
    s_cbranch_scc1 L_wf_2
    v_mov_b32 v249, s51
    v_mov_b32 v248, 0
    s_mov_b64 exec, 1
    buffer_store_dword v249, v248, s[44:47], s96 offen sc1
    s_mov_b64 exec, -1
L_wf_2:
    s_waitcnt lgkmcnt(8)
    s_add_u32 m0, s72, 14336
    s_cmp_gt_u32 s4, 31
    s_cselect_b32 s75, s1, s3
    s_add_u32 s75, s75, 1777664
    buffer_load_dwordx4 v2, s[24:27], s75 offen lds
    s_waitcnt vmcnt(18)
    ds_read_b64_tr_b16 a[176:177], v4 offset:20480
    ds_read_b64_tr_b16 a[178:179], v4 offset:20992
    buffer_load_dwordx4 v3, s[24:27], s75 offen offset:1024 lds
    ds_read_b64_tr_b16 a[180:181], v5 offset:20480
    ds_read_b64_tr_b16 a[182:183], v5 offset:20992
    v_lshlrev_b32 v244, 3, v240
    s_lshl_b32 s60, s52, 1
    s_lshr_b32 s61, s48, 1
    s_add_u32 s60, s60, s61
    s_lshl_b32 s60, s60, 6
    buffer_load_dwordx2 v[232:233], v244, s[28:31], s60 offen offset:0
    buffer_load_dwordx2 v[234:235], v244, s[28:31], s60 offen offset:16
    buffer_load_dwordx2 v[236:237], v244, s[28:31], s60 offen offset:32
    buffer_load_dwordx2 v[238:239], v244, s[28:31], s60 offen offset:48
    s_branch L_w1done
L_w1skip:
    s_waitcnt lgkmcnt(0)
    buffer_store_dwordx4 v[224:227], v242, s[44:47], s101 offen sc1
    s_add_u32 s101, s101, 1048576
    buffer_store_dwordx4 v[228:231], v243, s[44:47], s101 offen sc1
    s_cmp_lt_u32 s50, 25
    s_cselect_b32 s60, 0x80000000, 0
    v_lshrrev_b32 v13, 2, v0
    v_lshlrev_b32 v13, 12, v13
    v_and_b32 v14, 3, v0
    v_lshl_add_u32 v13, v14, 7, v13
    v_or_b32 v13, s60, v13
    s_sub_u32 s61, s50, 25
    s_max_i32 s61, s61, 0
    s_lshl_b32 s61, s61, 2
    s_add_u32 s61, s61, s48
    s_lshl_b32 s61, s61, 18
    s_lshl_b32 s66, s49, 9
    s_add_u32 s61, s61, s66
    buffer_load_dword v16, v13, s[32:35], s61 offen
    s_add_u32 s61, s61, 65536
    s_waitcnt vmcnt(1)
    s_barrier
    s_cmp_lg_u32 s48, 3
    s_cbranch_scc1 L_wf_3
    v_mov_b32 v249, s51
    v_mov_b32 v248, 0
    s_mov_b64 exec, 1
    buffer_store_dword v249, v248, s[44:47], s96 offen sc1
    s_mov_b64 exec, -1
L_wf_3:
    s_add_u32 s96, s96, 8192
    s_barrier
    s_cmp_lg_u32 s48, 2
    s_cbranch_scc1 L_wf_4
    v_mov_b32 v249, s51
    v_mov_b32 v248, 0
    s_mov_b64 exec, 1
    buffer_store_dword v249, v248, s[44:47], s96 offen sc1
    s_mov_b64 exec, -1
L_wf_4:
    buffer_load_dword v17, v13, s[32:35], s61 offen
    s_add_u32 s61, s61, 65536
    buffer_load_dword v18, v13, s[32:35], s61 offen
    s_add_u32 s61, s61, 65536
    buffer_load_dword v19, v13, s[32:35], s61 offen
    s_add_u32 s61, s61, 65536
    s_mov_b32 s100, s61
    v_mov_b32 v254, v13
    s_sub_u32 s61, s2, 200
    s_max_i32 s61, s61, 0
    s_lshl_b32 s61, s61, 2
    s_add_u32 s61, s61, s48
    s_mul_i32 s61, s61, 1792
    v_min_u32 v13, 13, v0
    v_lshl_or_b32 v13, v13, 7, s60
    buffer_load_dword v20, v13, s[20:23], s61 offen
L_notouch:
    v_lshrrev_b32 v245, 2, v0
    v_and_b32 v246, 3, v0
    v_lshlrev_b32 v246, 2, v246
    v_lshl_add_u32 v245, v245, 7, v246
    s_lshr_b32 s69, s48, 0
    s_and_b32 s69, s69, 1
    s_lshl_b32 s69, s69, 10
    v_add_u32 v6, s69, v1
    v_xor_b32 v7, 0x400, v6
    s_lshl_b32 s68, s53, 7
    s_lshl_b32 s69, s48, 5
    s_add_u32 s68, s68, s69
    s_lshl_b32 s68, s68, 11
    s_add_u32 s68, s68, 3145728
    s_mul_i32 s73, s53, 5
    s_sub_u32 s73, 32, s73
    s_mul_i32 s5, s53, 10240
    s_add_u32 s5, s5, s68
    s_sub_u32 s6, s5, 65536
    v_and_b32 v11, 1, v241
    v_xor_b32 v11, v11, v240
    v_bfe_u32 v12, v241, 2, 2
    v_lshl_or_b32 v11, v12, 1, v11
    v_and_b32 v12, 2, v241
    v_lshl_or_b32 v11, v12, 2, v11
    v_lshlrev_b32 v11, 3, v11
    v_lshl_or_b32 v11, v241, 7, v11
    s_lshl_b32 s65, s48, 12
    s_add_u32 s65, s65, 24576
    v_add_u32 v11, s65, v11
    v_subrev_u32 v12, s72, v10
    v_lshl_add_u32 v12, v240, 9, v12
    s_and_b32 s65, s48, 1
    s_lshl_b32 s65, s65, 6
    s_lshr_b32 s66, s48, 1
    s_lshl_b32 s66, s66, 5
    s_or_b32 s65, s65, s66
    v_xor_b32 v12, s65, v12
    v_bfe_u32 v13, v0, 2, 1
    v_lshlrev_b32 v13, 3, v13
    v_lshl_or_b32 v13, v240, 4, v13
    v_xor_b32 v12, v12, v13
    v_add_u32 v12, 24576, v12
    v_xor_b32 v13, 32, v12
    s_lshl_b32 s65, s48, 11
    s_add_u32 s65, s65, 40960
    v_add_u32 v14, s65, v1
    v_add_u32 v15, 40960, v1
    s_lshl_b32 s64, s55, 4
    s_add_u32 s64, s64, s56
    s_lshl_b32 s65, s64, 13
    s_and_b32 s66, s48, 1
    s_lshl_b32 s66, s66, 12
    s_add_u32 s65, s65, s66
    s_lshr_b32 s66, s48, 1
    s_lshl_b32 s66, s66, 11
    s_add_u32 s65, s65, s66
    s_add_u32 s65, s65, 11534336
    s_lshl_b32 s64, s64, 7
    s_add_u32 s64, s64, 262144
    s_mov_b32 s98, 0x10000000
    s_mov_b32 s99, 0x10000000
    v_cndmask_b32 v80, 0, 1.0, s[98:99]
    v_cndmask_b32 v81, 0, 1.0, s[98:99]
    v_cndmask_b32 v82, 0, 1.0, s[98:99]
    v_cndmask_b32 v83, 0, 1.0, s[98:99]
    v_cndmask_b32 v84, 0, 1.0, s[98:99]
    v_cndmask_b32 v85, 0, 1.0, s[98:99]
    v_cndmask_b32 v86, 0, 1.0, s[98:99]
    v_cndmask_b32 v87, 0, 1.0, s[98:99]
    v_cndmask_b32 v88, 0, 1.0, s[98:99]
    v_cndmask_b32 v89, 0, 1.0, s[98:99]
    v_cndmask_b32 v90, 0, 1.0, s[98:99]
    v_cndmask_b32 v91, 0, 1.0, s[98:99]
    v_cndmask_b32 v92, 0, 1.0, s[98:99]
    v_cndmask_b32 v93, 0, 1.0, s[98:99]
    v_cndmask_b32 v94, 0, 1.0, s[98:99]
    v_cndmask_b32 v95, 0, 1.0, s[98:99]
    s_waitcnt vmcnt(0) lgkmcnt(0)
    s_cmp_lg_u32 s48, 0
    s_cbranch_scc1 L_nopoll0
    s_waitcnt vmcnt(0)
    buffer_load_dword v250, v247, s[44:47], 0 offen sc1
    s_waitcnt vmcnt(0)
    s_mov_b32 s74, 200000
L_poll_5:
    v_cmp_ne_u32 vcc, s51, v250
    s_nop 1
    s_cmp_eq_u64 vcc, 0
    s_cbranch_scc1 L_pdone_6
    s_sleep 12
    buffer_load_dword v250, v247, s[44:47], 0 offen sc1
    s_waitcnt vmcnt(0)
    s_sub_u32 s74, s74, 1
    s_cmp_lg_u32 s74, 0
    s_cbranch_scc1 L_poll_5
L_pdone_6:
    s_branch L_nopoll0
L_w1done:
    s_cmp_lg_u32 s48, 0
    s_cbranch_scc1 L_nopoll0
    s_waitcnt vmcnt(14)
    s_mov_b32 s74, 200000
L_poll_7:
    v_cmp_ne_u32 vcc, s51, v250
    s_nop 1
    s_cmp_eq_u64 vcc, 0
    s_cbranch_scc1 L_pdone_8
    s_sleep 2
    buffer_load_dword v250, v247, s[44:47], 0 offen sc1
    s_waitcnt vmcnt(0)
    s_sub_u32 s74, s74, 1
    s_cmp_lg_u32 s74, 0
    s_cbranch_scc1 L_poll_7
L_pdone_8:
L_nopoll0:
    s_lshr_b32 s63, s2, 2
    s_lshl_b32 s63, s63, 7
    s_and_b32 s67, s2, 3
    s_lshl_b32 s67, s67, 2
    s_add_u32 s63, s63, s67
    s_add_u32 s63, s63, 8192
    s_lshl_b32 s67, s48, 11
    s_add_u32 s67, s67, 8192
    s_cmp_eq_u32 s59, 0
    s_cselect_b32 s22, 0, s22
    s_cselect_b32 s34, 0, s34
    s_mov_b32 s16, s44
    s_mov_b32 s17, s45
    s_cmp_eq_u32 s54, 0
    s_cselect_b32 s18, 0, 0x10000000
    s_mul_i32 s60, s55, 86016
    s_mul_i32 s61, s48, 3072
    s_add_u32 s60, s60, s61
    s_add_u32 s60, s60, 5242880
    s_lshl_b32 s62, s56, 2
    s_add_u32 s62, s62, s48
    s_mul_i32 s62, s62, 28672
    s_add_u32 s62, s62, 1048576
    s_barrier
    s_add_u32 m0, s61, 0
    s_nop 0
    buffer_load_dwordx4 v1, s[44:47], s60 offen offset:0 sc1 lds
    s_waitcnt vmcnt(22)
    ds_read_b64_tr_b16 a[184:185], v4 offset:22528
    ds_read_b64_tr_b16 a[186:187], v4 offset:23040
    buffer_load_dwordx4 v1, s[44:47], s60 offen offset:1024 sc1 lds
    ds_read_b64_tr_b16 a[188:189], v5 offset:22528
    ds_read_b64_tr_b16 a[190:191], v5 offset:23040
    buffer_load_dwordx4 v1, s[44:47], s60 offen offset:2048 sc1 lds
    s_waitcnt vmcnt(22)
    ds_read_b64_tr_b16 a[192:193], v4 offset:0
    ds_read_b64_tr_b16 a[194:195], v4 offset:512
    buffer_load_dwordx4 v[96:99], v1, s[44:47], s62 offen offset:0 sc1
    ds_read_b64_tr_b16 a[196:197], v5 offset:0
    ds_read_b64_tr_b16 a[198:199], v5 offset:512
    buffer_load_dwordx4 v[100:103], v1, s[44:47], s62 offen offset:1024 sc1
    s_waitcnt vmcnt(22)
    ds_read_b64_tr_b16 a[200:201], v4 offset:2048
    ds_read_b64_tr_b16 a[202:203], v4 offset:2560
    buffer_load_dwordx4 v[104:107], v1, s[44:47], s62 offen offset:2048 sc1
    ds_read_b64_tr_b16 a[204:205], v5 offset:2048
    ds_read_b64_tr_b16 a[206:207], v5 offset:2560
    buffer_load_dwordx4 v[108:111], v1, s[44:47], s62 offen offset:3072 sc1
    s_waitcnt vmcnt(22)
    ds_read_b64_tr_b16 a[208:209], v4 offset:4096
    ds_read_b64_tr_b16 a[210:211], v4 offset:4608
    s_add_u32 m0, s61, 12288
    s_add_u32 s60, s60, 12288
    buffer_load_dwordx4 v1, s[44:47], s60 offen offset:0 sc1 lds
    ds_read_b64_tr_b16 a[212:213], v5 offset:4096
    ds_read_b64_tr_b16 a[214:215], v5 offset:4608
    buffer_load_dwordx4 v1, s[44:47], s60 offen offset:1024 sc1 lds
    s_waitcnt vmcnt(21)
    ds_read_b64_tr_b16 a[216:217], v4 offset:6144
    ds_read_b64_tr_b16 a[218:219], v4 offset:6656
    buffer_load_dwordx4 v1, s[44:47], s60 offen offset:2048 sc1 lds
    ds_read_b64_tr_b16 a[220:221], v5 offset:6144
    ds_read_b64_tr_b16 a[222:223], v5 offset:6656
    s_add_u32 s62, s62, 4096
    buffer_load_dwordx4 v[112:115], v1, s[44:47], s62 offen offset:0 sc1
    s_waitcnt vmcnt(21)
    ds_read_b64_tr_b16 a[224:225], v4 offset:8192
    ds_read_b64_tr_b16 a[226:227], v4 offset:8704
    buffer_load_dwordx4 v[116:119], v1, s[44:47], s62 offen offset:1024 sc1
    ds_read_b64_tr_b16 a[228:229], v5 offset:8192
    ds_read_b64_tr_b16 a[230:231], v5 offset:8704
    s_waitcnt vmcnt(20)
    ds_read_b64_tr_b16 a[232:233], v4 offset:10240
    ds_read_b64_tr_b16 a[234:235], v4 offset:10752
    ds_read_b64_tr_b16 a[236:237], v5 offset:10240
    ds_read_b64_tr_b16 a[238:239], v5 offset:10752
    s_waitcnt vmcnt(18)
    ds_read_b64_tr_b16 a[240:241], v4 offset:12288
    ds_read_b64_tr_b16 a[242:243], v4 offset:12800
    ds_read_b64_tr_b16 a[244:245], v5 offset:12288
    ds_read_b64_tr_b16 a[246:247], v5 offset:12800
    s_waitcnt vmcnt(16)
    ds_read_b64_tr_b16 a[248:249], v4 offset:14336
    ds_read_b64_tr_b16 a[250:251], v4 offset:14848
    ds_read_b64_tr_b16 a[252:253], v5 offset:14336
    ds_read_b64_tr_b16 a[254:255], v5 offset:14848
    s_waitcnt vmcnt(9)
    s_barrier
    ds_read_b128 v[156:159], v1 offset:1024
    ds_read_b128 v[160:163], v1 offset:2048
    ds_read_b128 v[152:155], v1 offset:0
    ds_read_b128 v[168:171], v1 offset:4096
    ds_read_b128 v[172:175], v1 offset:5120
    ds_read_b128 v[164:167], v1 offset:3072
    s_waitcnt vmcnt(8)
    s_waitcnt lgkmcnt(3)
    v_mfma_f32_32x32x16_bf16 v[192:207], v[156:159], v[96:99], 0
    buffer_load_dwordx4 v[120:123], v1, s[44:47], s62 offen offset:2048 sc1
    ds_read_b128 v[180:183], v1 offset:7168
    v_mfma_f32_32x32x16_bf16 v[80:95], v[96:99], v[160:163], v[80:95]
    buffer_load_dwordx4 v[124:127], v1, s[44:47], s62 offen offset:3072 sc1
    v_mfma_f32_32x32x16_bf16 v[208:223], v[152:155], v[96:99], 0
    ds_read_b128 v[184:187], v1 offset:8192
    ds_read_b128 v[176:179], v1 offset:6144
    s_waitcnt vmcnt(9)
    s_waitcnt lgkmcnt(3)
    v_mfma_f32_32x32x16_bf16 v[192:207], v[168:171], v[100:103], v[192:207]
    s_add_u32 m0, s61, 24576
    s_add_u32 s60, s60, 12288
    buffer_load_dwordx4 v1, s[44:47], s60 offen offset:0 sc1 lds
    v_mfma_f32_32x32x16_bf16 v[80:95], v[100:103], v[172:175], v[80:95]
    ds_read_b128 v[156:159], v1 offset:10240
    buffer_load_dwordx4 v1, s[44:47], s60 offen offset:1024 sc1 lds
    v_mfma_f32_32x32x16_bf16 v[208:223], v[164:167], v[100:103], v[208:223]
    ds_read_b128 v[160:163], v1 offset:11264
    ds_read_b128 v[152:155], v1 offset:9216
    s_waitcnt vmcnt(10)
    s_waitcnt lgkmcnt(3)
    v_mfma_f32_32x32x16_bf16 v[192:207], v[180:183], v[104:107], v[192:207]
    buffer_load_dwordx4 v1, s[44:47], s60 offen offset:2048 sc1 lds
    s_waitcnt vmcnt(7)
    s_barrier
    v_mfma_f32_32x32x16_bf16 v[80:95], v[104:107], v[184:187], v[80:95]
    ds_read_b128 v[168:171], v1 offset:13312
    s_add_u32 s62, s62, 4096
    buffer_load_dwordx4 v[128:131], v1, s[44:47], s62 offen offset:0 sc1
    v_mfma_f32_32x32x16_bf16 v[208:223], v[176:179], v[104:107], v[208:223]
    ds_read_b128 v[172:175], v1 offset:14336
    ds_read_b128 v[164:167], v1 offset:12288
    s_waitcnt lgkmcnt(3)
    v_mfma_f32_32x32x16_bf16 v[192:207], v[156:159], v[108:111], v[192:207]
    buffer_load_dwordx4 v[132:135], v1, s[44:47], s62 offen offset:1024 sc1
    ds_read_b128 v[180:183], v1 offset:16384
    v_mfma_f32_32x32x16_bf16 v[80:95], v[108:111], v[160:163], v[80:95]
    buffer_load_dwordx4 v[136:139], v1, s[44:47], s62 offen offset:2048 sc1
    v_mfma_f32_32x32x16_bf16 v[208:223], v[152:155], v[108:111], v[208:223]
    ds_read_b128 v[184:187], v1 offset:17408
    ds_read_b128 v[176:179], v1 offset:15360
    s_waitcnt vmcnt(9)
    s_waitcnt lgkmcnt(3)
    v_mfma_f32_32x32x16_bf16 v[192:207], v[168:171], v[112:115], v[192:207]
    buffer_load_dwordx4 v[140:143], v1, s[44:47], s62 offen offset:3072 sc1
    ds_read_b128 v[156:159], v1 offset:19456
    v_mfma_f32_32x32x16_bf16 v[80:95], v[112:115], v[172:175], v[80:95]
    s_add_u32 m0, s61, 36864
    s_add_u32 s60, s60, 12288
    buffer_load_dwordx4 v1, s[44:47], s60 offen offset:0 sc1 lds
    v_mfma_f32_32x32x16_bf16 v[208:223], v[164:167], v[112:115], v[208:223]
    ds_read_b128 v[160:163], v1 offset:20480
    ds_read_b128 v[152:155], v1 offset:18432
    s_waitcnt vmcnt(10)
    s_waitcnt lgkmcnt(3)
    v_mfma_f32_32x32x16_bf16 v[192:207], v[180:183], v[116:119], v[192:207]
    buffer_load_dwordx4 v1, s[44:47], s60 offen offset:1024 sc1 lds
    ds_read_b128 v[168:171], v1 offset:22528
    v_mfma_f32_32x32x16_bf16 v[80:95], v[116:119], v[184:187], v[80:95]
    buffer_load_dwordx4 v1, s[44:47], s60 offen offset:2048 sc1 lds
    v_mfma_f32_32x32x16_bf16 v[208:223], v[176:179], v[116:119], v[208:223]
    ds_read_b128 v[172:175], v1 offset:23552
    ds_read_b128 v[164:167], v1 offset:21504
    s_waitcnt vmcnt(11)
    s_waitcnt lgkmcnt(3)
    v_mfma_f32_32x32x16_bf16 v[192:207], v[156:159], v[120:123], v[192:207]
    s_add_u32 s62, s62, 4096
    buffer_load_dwordx4 v[144:147], v1, s[44:47], s62 offen offset:0 sc1
    s_waitcnt vmcnt(8)
    v_mfma_f32_32x32x16_bf16 v[80:95], v[120:123], v[160:163], v[80:95]
    s_barrier
    ds_read_b128 v[180:183], v1 offset:25600
    buffer_load_dwordx4 v[148:151], v1, s[44:47], s62 offen offset:1024 sc1
    v_mfma_f32_32x32x16_bf16 v[208:223], v[152:155], v[120:123], v[208:223]
    ds_read_b128 v[184:187], v1 offset:26624
    ds_read_b128 v[176:179], v1 offset:24576
    s_waitcnt lgkmcnt(3)
    v_mfma_f32_32x32x16_bf16 v[192:207], v[168:171], v[124:127], v[192:207]
    buffer_load_dwordx4 v[24:27], v1, s[44:47], s62 offen offset:2048 sc1
    ds_read_b128 v[156:159], v1 offset:28672
    v_mfma_f32_32x32x16_bf16 v[80:95], v[124:127], v[172:175], v[80:95]
    buffer_load_dwordx4 v[28:31], v1, s[44:47], s62 offen offset:3072 sc1
    v_mfma_f32_32x32x16_bf16 v[208:223], v[164:167], v[124:127], v[208:223]
    ds_read_b128 v[160:163], v1 offset:29696
    ds_read_b128 v[152:155], v1 offset:27648
    s_waitcnt vmcnt(10)
    s_waitcnt lgkmcnt(3)
    v_mfma_f32_32x32x16_bf16 v[192:207], v[180:183], v[128:131], v[192:207]
    s_add_u32 m0, s61, 49152
    s_add_u32 s60, s60, 12288
    buffer_load_dwordx4 v1, s[44:47], s60 offen offset:0 sc1 lds
    v_mfma_f32_32x32x16_bf16 v[80:95], v[128:131], v[184:187], v[80:95]
    ds_read_b128 v[168:171], v1 offset:31744
    buffer_load_dwordx4 v1, s[44:47], s60 offen offset:1024 sc1 lds
    v_mfma_f32_32x32x16_bf16 v[208:223], v[176:179], v[128:131], v[208:223]
    ds_read_b128 v[172:175], v1 offset:32768
    ds_read_b128 v[164:167], v1 offset:30720
    s_waitcnt vmcnt(11)
    s_waitcnt lgkmcnt(3)
    v_mfma_f32_32x32x16_bf16 v[192:207], v[156:159], v[132:135], v[192:207]
    buffer_load_dwordx4 v1, s[44:47], s60 offen offset:2048 sc1 lds
    ds_read_b128 v[180:183], v1 offset:34816
    v_mfma_f32_32x32x16_bf16 v[80:95], v[132:135], v[160:163], v[80:95]
    s_add_u32 s62, s62, 4096
    buffer_load_dwordx4 v[32:35], v1, s[44:47], s62 offen offset:0 sc1
    v_mfma_f32_32x32x16_bf16 v[208:223], v[152:155], v[132:135], v[208:223]
    ds_read_b128 v[184:187], v1 offset:35840
    ds_read_b128 v[176:179], v1 offset:33792
    s_waitcnt vmcnt(12)
    s_waitcnt lgkmcnt(3)
    v_mfma_f32_32x32x16_bf16 v[192:207], v[168:171], v[136:139], v[192:207]
    buffer_load_dwordx4 v[36:39], v1, s[44:47], s62 offen offset:1024 sc1
    s_waitcnt vmcnt(9)
    s_barrier
    v_mfma_f32_32x32x16_bf16 v[80:95], v[136:139], v[172:175], v[80:95]
    ds_read_b128 v[156:159], v1 offset:37888
    buffer_load_dwordx4 v[40:43], v1, s[44:47], s62 offen offset:2048 sc1
    v_mfma_f32_32x32x16_bf16 v[208:223], v[164:167], v[136:139], v[208:223]
    ds_read_b128 v[160:163], v1 offset:38912
    ds_read_b128 v[152:155], v1 offset:36864
    s_waitcnt lgkmcnt(3)
    v_mfma_f32_32x32x16_bf16 v[192:207], v[180:183], v[140:143], v[192:207]
    buffer_load_dwordx4 v[44:47], v1, s[44:47], s62 offen offset:3072 sc1
    ds_read_b128 v[168:171], v1 offset:40960
    v_mfma_f32_32x32x16_bf16 v[80:95], v[140:143], v[184:187], v[80:95]
    s_add_u32 m0, s61, 0
    s_add_u32 s60, s60, 12288
    buffer_load_dwordx4 v1, s[44:47], s60 offen offset:0 sc1 lds
    v_mfma_f32_32x32x16_bf16 v[208:223], v[176:179], v[140:143], v[208:223]
    ds_read_b128 v[172:175], v1 offset:41984
    ds_read_b128 v[164:167], v1 offset:39936
    s_waitcnt vmcnt(11)
    s_waitcnt lgkmcnt(3)
    v_mfma_f32_32x32x16_bf16 v[192:207], v[156:159], v[144:147], v[192:207]
    buffer_load_dword v250, v245, s[44:47], s67 offen sc1
    ds_read_b128 v[180:183], v1 offset:44032
    v_mfma_f32_32x32x16_bf16 v[80:95], v[144:147], v[160:163], v[80:95]
    buffer_load_dwordx4 v1, s[44:47], s60 offen offset:1024 sc1 lds
    buffer_load_dwordx4 v1, s[44:47], s60 offen offset:2048 sc1 lds
    v_mfma_f32_32x32x16_bf16 v[208:223], v[152:155], v[144:147], v[208:223]
    ds_read_b128 v[184:187], v1 offset:45056
    ds_read_b128 v[176:179], v1 offset:43008
    s_waitcnt vmcnt(13)
    s_waitcnt lgkmcnt(3)
    v_mfma_f32_32x32x16_bf16 v[192:207], v[168:171], v[148:151], v[192:207]
    s_add_u32 s62, s62, 4096
    buffer_load_dwordx4 v[48:51], v1, s[44:47], s62 offen offset:0 sc1
    v_mfma_f32_32x32x16_bf16 v[80:95], v[148:151], v[172:175], v[80:95]
    ds_read_b128 v[156:159], v1 offset:47104
    buffer_load_dwordx4 v[52:55], v1, s[44:47], s62 offen offset:1024 sc1
    v_mfma_f32_32x32x16_bf16 v[208:223], v[164:167], v[148:151], v[208:223]
    ds_read_b128 v[160:163], v1 offset:48128
    ds_read_b128 v[152:155], v1 offset:46080
    s_waitcnt vmcnt(14)
    s_waitcnt lgkmcnt(3)
    v_mfma_f32_32x32x16_bf16 v[192:207], v[180:183], v[24:27], v[192:207]
    buffer_load_dwordx4 v[56:59], v1, s[44:47], s62 offen offset:2048 sc1
    s_waitcnt vmcnt(11)
    s_barrier
    v_mfma_f32_32x32x16_bf16 v[80:95], v[24:27], v[184:187], v[80:95]
    ds_read_b128 v[168:171], v1 offset:50176
    buffer_load_dwordx4 v[60:63], v1, s[44:47], s62 offen offset:3072 sc1
    v_mfma_f32_32x32x16_bf16 v[208:223], v[176:179], v[24:27], v[208:223]
    ds_read_b128 v[172:175], v1 offset:51200
    ds_read_b128 v[164:167], v1 offset:49152
    s_waitcnt lgkmcnt(3)
    v_mfma_f32_32x32x16_bf16 v[192:207], v[156:159], v[28:31], v[192:207]
    s_add_u32 m0, s61, 12288
    s_add_u32 s60, s60, 12288
    buffer_load_dwordx4 v1, s[44:47], s60 offen offset:0 sc1 lds
    v_mfma_f32_32x32x16_bf16 v[80:95], v[28:31], v[160:163], v[80:95]
    ds_read_b128 v[180:183], v1 offset:53248
    buffer_load_dwordx4 v1, s[44:47], s60 offen offset:1024 sc1 lds
    v_mfma_f32_32x32x16_bf16 v[208:223], v[152:155], v[28:31], v[208:223]
    ds_read_b128 v[184:187], v1 offset:54272
    ds_read_b128 v[176:179], v1 offset:52224
    s_waitcnt vmcnt(13)
    s_waitcnt lgkmcnt(3)
    v_mfma_f32_32x32x16_bf16 v[192:207], v[168:171], v[32:35], v[192:207]
    buffer_load_dwordx4 v1, s[44:47], s60 offen offset:2048 sc1 lds
    ds_read_b128 v[156:159], v1 offset:56320
    v_mfma_f32_32x32x16_bf16 v[80:95], v[32:35], v[172:175], v[80:95]
    s_add_u32 s62, s62, 4096
    buffer_load_dwordx4 v[64:67], v1, s[44:47], s62 offen offset:0 sc1
    v_mfma_f32_32x32x16_bf16 v[208:223], v[164:167], v[32:35], v[208:223]
    ds_read_b128 v[160:163], v1 offset:57344
    ds_read_b128 v[152:155], v1 offset:55296
    s_waitcnt vmcnt(14)
    s_waitcnt lgkmcnt(3)
    v_mfma_f32_32x32x16_bf16 v[192:207], v[180:183], v[36:39], v[192:207]
    buffer_load_dwordx4 v[68:71], v1, s[44:47], s62 offen offset:1024 sc1
    ds_read_b128 v[168:171], v1 offset:59392
    v_mfma_f32_32x32x16_bf16 v[80:95], v[36:39], v[184:187], v[80:95]
    buffer_load_dwordx4 v[72:75], v1, s[44:47], s62 offen offset:2048 sc1
    v_mfma_f32_32x32x16_bf16 v[208:223], v[176:179], v[36:39], v[208:223]
    ds_read_b128 v[172:175], v1 offset:60416
    ds_read_b128 v[164:167], v1 offset:58368
    s_waitcnt vmcnt(15)
    s_waitcnt lgkmcnt(3)
    v_mfma_f32_32x32x16_bf16 v[192:207], v[156:159], v[40:43], v[192:207]
    s_waitcnt vmcnt(12)
    s_mov_b32 s74, 200000
L_poll_9:
    v_cmp_ne_u32 vcc, s51, v250
    s_nop 1
    s_cmp_eq_u64 vcc, 0
    s_cbranch_scc1 L_pdone_10
    s_sleep 2
    buffer_load_dword v250, v245, s[44:47], s67 offen sc1
    s_waitcnt vmcnt(0)
    s_sub_u32 s74, s74, 1
    s_cmp_lg_u32 s74, 0
    s_cbranch_scc1 L_poll_9
L_pdone_10:
    v_mfma_f32_32x32x16_bf16 v[80:95], v[40:43], v[160:163], v[80:95]
    s_waitcnt vmcnt(10)
    s_barrier
    ds_read_b128 v[180:183], v1 offset:1024
    v_mfma_f32_32x32x16_bf16 v[208:223], v[152:155], v[40:43], v[208:223]
    buffer_load_dwordx4 v[76:79], v1, s[44:47], s62 offen offset:3072 sc1
    ds_read_b128 v[184:187], v1 offset:2048
    ds_read_b128 v[176:179], v1 offset:0
    s_waitcnt lgkmcnt(3)
    v_mfma_f32_32x32x16_bf16 v[192:207], v[168:171], v[44:47], v[192:207]
    s_cmp_gt_u32 s73, 0
    s_cselect_b32 s7, s5, s6
    buffer_load_dwordx4 v[96:99], v6, s[16:19], s7 offen sc1
    v_mfma_f32_32x32x16_bf16 v[80:95], v[44:47], v[172:175], v[80:95]
    ds_read_b128 v[156:159], v1 offset:4096
    buffer_load_dwordx4 v[100:103], v7, s[16:19], s7 offen sc1
    v_mfma_f32_32x32x16_bf16 v[208:223], v[164:167], v[44:47], v[208:223]
    ds_read_b128 v[160:163], v1 offset:5120
    ds_read_b128 v[152:155], v1 offset:3072
    s_waitcnt vmcnt(12)
    s_waitcnt lgkmcnt(3)
    v_mfma_f32_32x32x16_bf16 v[192:207], v[180:183], v[48:51], v[192:207]
    s_cmp_gt_u32 s73, 1
    s_cselect_b32 s7, s5, s6
    s_add_u32 s7, s7, 2048
    v_mfma_f32_32x32x16_bf16 v[80:95], v[48:51], v[184:187], v[80:95]
    buffer_load_dwordx4 v[104:107], v6, s[16:19], s7 offen sc1
    ds_read_b128 v[168:171], v1 offset:7168
    v_mfma_f32_32x32x16_bf16 v[208:223], v[176:179], v[48:51], v[208:223]
    ds_read_b128 v[172:175], v1 offset:8192
    ds_read_b128 v[164:167], v1 offset:6144
    s_waitcnt vmcnt(12)
    s_waitcnt lgkmcnt(3)
    v_mfma_f32_32x32x16_bf16 v[192:207], v[156:159], v[52:55], v[192:207]
    buffer_load_dwordx4 v[108:111], v7, s[16:19], s7 offen sc1
    ds_read_b128 v[180:183], v1 offset:10240
    v_mfma_f32_32x32x16_bf16 v[80:95], v[52:55], v[160:163], v[80:95]
    s_cmp_gt_u32 s73, 2
    s_cselect_b32 s7, s5, s6
    s_add_u32 s7, s7, 4096
    buffer_load_dwordx4 v[112:115], v6, s[16:19], s7 offen sc1
    v_mfma_f32_32x32x16_bf16 v[208:223], v[152:155], v[52:55], v[208:223]
    ds_read_b128 v[184:187], v1 offset:11264
    ds_read_b128 v[176:179], v1 offset:9216
    s_waitcnt vmcnt(13)
    s_waitcnt lgkmcnt(3)
    v_mfma_f32_32x32x16_bf16 v[192:207], v[168:171], v[56:59], v[192:207]
    buffer_load_dwordx4 v[116:119], v7, s[16:19], s7 offen sc1
    s_waitcnt vmcnt(10)
    v_mfma_f32_32x32x16_bf16 v[80:95], v[56:59], v[172:175], v[80:95]
    s_barrier
    ds_read_b128 v[156:159], v1 offset:13312
    v_mfma_f32_32x32x16_bf16 v[208:223], v[164:167], v[56:59], v[208:223]
    ds_read_b128 v[160:163], v1 offset:14336
    ds_read_b128 v[152:155], v1 offset:12288
    s_waitcnt lgkmcnt(3)
    v_mfma_f32_32x32x16_bf16 v[192:207], v[180:183], v[60:63], v[192:207]
    s_cmp_gt_u32 s73, 3
    s_cselect_b32 s7, s5, s6
    s_add_u32 s7, s7, 6144
    v_mfma_f32_32x32x16_bf16 v[80:95], v[60:63], v[184:187], v[80:95]
    buffer_load_dwordx4 v[120:123], v6, s[16:19], s7 offen sc1
    ds_read_b128 v[168:171], v1 offset:16384
    buffer_load_dwordx4 v[124:127], v7, s[16:19], s7 offen sc1
    v_mfma_f32_32x32x16_bf16 v[208:223], v[176:179], v[60:63], v[208:223]
    ds_read_b128 v[172:175], v1 offset:17408
    ds_read_b128 v[164:167], v1 offset:15360
    s_waitcnt vmcnt(11)
    s_waitcnt lgkmcnt(3)
    v_mfma_f32_32x32x16_bf16 v[192:207], v[156:159], v[64:67], v[192:207]
    s_cmp_gt_u32 s73, 4
    s_cselect_b32 s7, s5, s6
    s_add_u32 s7, s7, 8192
    v_mfma_f32_32x32x16_bf16 v[80:95], v[64:67], v[160:163], v[80:95]
    buffer_load_dwordx4 v[128:131], v6, s[16:19], s7 offen sc1
    ds_read_b128 v[180:183], v1 offset:19456
    v_mfma_f32_32x32x16_bf16 v[208:223], v[152:155], v[64:67], v[208:223]
    ds_read_b128 v[184:187], v1 offset:20480
    ds_read_b128 v[176:179], v1 offset:18432
    s_waitcnt vmcnt(11)
    s_waitcnt lgkmcnt(3)
    v_mfma_f32_32x32x16_bf16 v[192:207], v[168:171], v[68:71], v[192:207]
    buffer_load_dwordx4 v[132:135], v7, s[16:19], s7 offen sc1
    ds_read_b128 v[156:159], v1 offset:22528
    v_mfma_f32_32x32x16_bf16 v[80:95], v[68:71], v[172:175], v[80:95]
    s_cmp_gt_u32 s73, 5
    s_cselect_b32 s7, s5, s6
    s_add_u32 s7, s7, 10240
    buffer_load_dwordx4 v[136:139], v6, s[16:19], s7 offen sc1
    v_mfma_f32_32x32x16_bf16 v[208:223], v[164:167], v[68:71], v[208:223]
    ds_read_b128 v[160:163], v1 offset:23552
    ds_read_b128 v[152:155], v1 offset:21504
    s_waitcnt vmcnt(12)
    s_waitcnt lgkmcnt(3)
    v_mfma_f32_32x32x16_bf16 v[192:207], v[180:183], v[72:75], v[192:207]
    buffer_load_dwordx4 v[140:143], v7, s[16:19], s7 offen sc1
    v_lshlrev_b32 v16, 16, v232
    v_mfma_f32_32x32x16_bf16 v[80:95], v[72:75], v[184:187], v[80:95]
    v_and_b32 v17, s0, v232
    v_lshlrev_b32 v18, 16, v233
    v_and_b32 v19, s0, v233
    v_lshlrev_b32 v20, 16, v234
    v_mfma_f32_32x32x16_bf16 v[208:223], v[176:179], v[72:75], v[208:223]
    v_and_b32 v21, s0, v234
    v_lshlrev_b32 v22, 16, v235
    v_and_b32 v23, s0, v235
    s_waitcnt vmcnt(12)
    s_waitcnt lgkmcnt(0)
    v_mfma_f32_32x32x16_bf16 v[192:207], v[156:159], v[76:79], v[192:207]
    s_cmp_gt_u32 s73, 6
    s_cselect_b32 s7, s5, s6
    s_add_u32 s7, s7, 12288
    buffer_load_dwordx4 v[144:147], v6, s[16:19], s7 offen sc1
    v_mfma_f32_32x32x16_bf16 v[80:95], v[76:79], v[160:163], v[80:95]
    v_lshlrev_b32 v24, 16, v236
    v_and_b32 v25, s0, v236
    v_lshlrev_b32 v26, 16, v237
    v_and_b32 v27, s0, v237
    v_lshlrev_b32 v28, 16, v238
    v_mfma_f32_32x32x16_bf16 v[208:223], v[152:155], v[76:79], v[208:223]
    v_and_b32 v29, s0, v238
    v_lshlrev_b32 v30, 16, v239
    v_and_b32 v31, s0, v239
    buffer_load_dwordx4 v[148:151], v7, s[16:19], s7 offen sc1
    s_cmp_eq_u32 s54, 0
    s_cbranch_scc1 L_nog1
    s_waitcnt vmcnt(12)
    v_mfma_f32_32x32x16_bf16 v[16:31], a[0:3], v[96:99], v[16:31]
    v_mfma_f32_32x32x16_bf16 v[32:47], a[0:3], v[100:103], 0
    v_mfma_f32_32x32x16_bf16 v[48:63], a[4:7], v[96:99], 0
    v_mfma_f32_32x32x16_bf16 v[64:79], a[4:7], v[100:103], 0
    s_waitcnt vmcnt(10)
    v_mfma_f32_32x32x16_bf16 v[16:31], a[8:11], v[104:107], v[16:31]
    s_cmp_gt_u32 s73, 7
    s_cselect_b32 s7, s5, s6
    s_add_u32 s7, s7, 14336
    buffer_load_dwordx4 v[96:99], v6, s[16:19], s7 offen sc1
    v_cvt_pk_bf16_f32 v80, v80, v81
    v_cvt_pk_bf16_f32 v81, v82, v83
    v_mfma_f32_32x32x16_bf16 v[32:47], a[8:11], v[108:111], v[32:47]
    v_cvt_pk_bf16_f32 v82, v84, v85
    v_cvt_pk_bf16_f32 v83, v86, v87
    v_cvt_pk_bf16_f32 v84, v88, v89
    buffer_load_dwordx4 v[100:103], v7, s[16:19], s7 offen sc1
    v_cvt_pk_bf16_f32 v85, v90, v91
    v_cvt_pk_bf16_f32 v86, v92, v93
    v_cvt_pk_bf16_f32 v87, v94, v95
    v_mfma_f32_32x32x16_bf16 v[48:63], a[12:15], v[104:107], v[48:63]
    ds_write_b128 v14, v[80:83]
    v_mfma_f32_32x32x16_bf16 v[64:79], a[12:15], v[108:111], v[64:79]
    ds_write_b128 v14, v[84:87] offset:1024
    s_waitcnt vmcnt(10)
    v_mfma_f32_32x32x16_bf16 v[16:31], a[16:19], v[112:115], v[16:31]
    s_cmp_gt_u32 s73, 8
    s_cselect_b32 s7, s5, s6
    s_add_u32 s7, s7, 16384
    buffer_load_dwordx4 v[104:107], v6, s[16:19], s7 offen sc1
    v_max3_f32 v184, v192, v193, v194
    v_max3_f32 v185, v195, v196, v197
    v_mfma_f32_32x32x16_bf16 v[32:47], a[16:19], v[116:119], v[32:47]
    v_min3_f32 v186, v192, v193, v194
    v_min3_f32 v187, v195, v196, v197
    v_max3_f32 v184, v184, v198, v199
    v_max3_f32 v185, v185, v200, v201
    v_min3_f32 v186, v186, v198, v199
    v_min3_f32 v187, v187, v200, v201
    v_max3_f32 v184, v184, v202, v203
    v_mfma_f32_32x32x16_bf16 v[48:63], a[20:23], v[112:115], v[48:63]
    v_max3_f32 v185, v185, v204, v205
    buffer_load_dwordx4 v[108:111], v7, s[16:19], s7 offen sc1
    v_min3_f32 v186, v186, v202, v203
    v_min3_f32 v187, v187, v204, v205
    v_max_f32 v188, v184, v185
    v_mfma_f32_32x32x16_bf16 v[64:79], a[20:23], v[116:119], v[64:79]
    v_max_f32 v184, v184, v185
    v_min_f32 v189, v186, v187
    v_min_f32 v186, v186, v187
    v_mov_b32 v190, 0x3fb8aa3b
    v_permlane32_swap_b32 v184, v188
    v_permlane32_swap_b32 v186, v189
    v_max_f32 v184, v184, v188
    s_waitcnt vmcnt(10)
    v_mfma_f32_32x32x16_bf16 v[16:31], a[24:27], v[120:123], v[16:31]
    s_cmp_gt_u32 s73, 9
    s_cselect_b32 s7, s5, s6
    s_add_u32 s7, s7, 18432
    buffer_load_dwordx4 v[112:115], v6, s[16:19], s7 offen sc1
    v_min_f32 v186, v186, v189
    v_mul_f32 v184, v190, v184
    v_mfma_f32_32x32x16_bf16 v[32:47], a[24:27], v[124:127], v[32:47]
    v_mul_f32 v186, v190, v186
    v_fma_f32 v152, v192, v190, -v184
    v_fma_f32 v168, -v192, v190, v186
    v_fma_f32 v153, v193, v190, -v184
    v_fma_f32 v169, -v193, v190, v186
    v_exp_f32 v152, v152
    v_mfma_f32_32x32x16_bf16 v[48:63], a[28:31], v[120:123], v[48:63]
    buffer_load_dwordx4 v[116:119], v7, s[16:19], s7 offen sc1
    v_exp_f32 v168, v168
    v_fma_f32 v154, v194, v190, -v184
    v_fma_f32 v170, -v194, v190, v186
    v_exp_f32 v153, v153
    v_mfma_f32_32x32x16_bf16 v[64:79], a[28:31], v[124:127], v[64:79]
    v_exp_f32 v169, v169
    v_fma_f32 v155, v195, v190, -v184
    v_fma_f32 v171, -v195, v190, v186
    v_exp_f32 v154, v154
    s_waitcnt vmcnt(10)
    v_mfma_f32_32x32x16_bf16 v[16:31], a[32:35], v[128:131], v[16:31]
    s_cmp_gt_u32 s73, 10
    s_cselect_b32 s7, s5, s6
    s_add_u32 s7, s7, 20480
    buffer_load_dwordx4 v[120:123], v6, s[16:19], s7 offen sc1
    v_exp_f32 v170, v170
    v_mfma_f32_32x32x16_bf16 v[32:47], a[32:35], v[132:135], v[32:47]
    v_fma_f32 v156, v196, v190, -v184
    v_fma_f32 v172, -v196, v190, v186
    v_exp_f32 v155, v155
    v_exp_f32 v171, v171
    v_fma_f32 v157, v197, v190, -v184
    v_mfma_f32_32x32x16_bf16 v[48:63], a[36:39], v[128:131], v[48:63]
    buffer_load_dwordx4 v[124:127], v7, s[16:19], s7 offen sc1
    v_fma_f32 v173, -v197, v190, v186
    v_exp_f32 v156, v156
    v_exp_f32 v172, v172
    v_mfma_f32_32x32x16_bf16 v[64:79], a[36:39], v[132:135], v[64:79]
    v_fma_f32 v158, v198, v190, -v184
    v_fma_f32 v174, -v198, v190, v186
    v_exp_f32 v157, v157
    v_exp_f32 v173, v173
    s_waitcnt vmcnt(10)
    v_mfma_f32_32x32x16_bf16 v[16:31], a[40:43], v[136:139], v[16:31]
    s_cmp_gt_u32 s73, 11
    s_cselect_b32 s7, s5, s6
    s_add_u32 s7, s7, 22528
    buffer_load_dwordx4 v[128:131], v6, s[16:19], s7 offen sc1
    v_fma_f32 v159, v199, v190, -v184
    v_fma_f32 v175, -v199, v190, v186
    v_mfma_f32_32x32x16_bf16 v[32:47], a[40:43], v[140:143], v[32:47]
    v_exp_f32 v158, v158
    v_exp_f32 v174, v174
    v_fma_f32 v160, v200, v190, -v184
    v_fma_f32 v176, -v200, v190, v186
    v_mfma_f32_32x32x16_bf16 v[48:63], a[44:47], v[136:139], v[48:63]
    v_exp_f32 v159, v159
    buffer_load_dwordx4 v[132:135], v7, s[16:19], s7 offen sc1
    v_exp_f32 v175, v175
    v_fma_f32 v161, v201, v190, -v184
    v_mfma_f32_32x32x16_bf16 v[64:79], a[44:47], v[140:143], v[64:79]
    v_fma_f32 v177, -v201, v190, v186
    v_exp_f32 v160, v160
    v_exp_f32 v176, v176
    v_fma_f32 v162, v202, v190, -v184
    v_fma_f32 v178, -v202, v190, v186
    s_waitcnt vmcnt(10)
    v_mfma_f32_32x32x16_bf16 v[16:31], a[48:51], v[144:147], v[16:31]
    s_cmp_gt_u32 s73, 12
    s_cselect_b32 s7, s5, s6
    s_add_u32 s7, s7, 24576
    buffer_load_dwordx4 v[136:139], v6, s[16:19], s7 offen sc1
    v_exp_f32 v161, v161
    v_mfma_f32_32x32x16_bf16 v[32:47], a[48:51], v[148:151], v[32:47]
    v_exp_f32 v177, v177
    v_fma_f32 v163, v203, v190, -v184
    v_fma_f32 v179, -v203, v190, v186
    v_exp_f32 v162, v162
    v_mfma_f32_32x32x16_bf16 v[48:63], a[52:55], v[144:147], v[48:63]
    v_exp_f32 v178, v178
    buffer_load_dwordx4 v[140:143], v7, s[16:19], s7 offen sc1
    v_fma_f32 v164, v204, v190, -v184
    v_fma_f32 v180, -v204, v190, v186
    v_exp_f32 v163, v163
    v_mfma_f32_32x32x16_bf16 v[64:79], a[52:55], v[148:151], v[64:79]
    v_exp_f32 v179, v179
    v_fma_f32 v165, v205, v190, -v184
    v_fma_f32 v181, -v205, v190, v186
    v_exp_f32 v164, v164
    s_waitcnt vmcnt(10)
    v_mfma_f32_32x32x16_bf16 v[16:31], a[56:59], v[96:99], v[16:31]
    s_cmp_gt_u32 s73, 13
    s_cselect_b32 s7, s5, s6
    s_add_u32 s7, s7, 26624
    buffer_load_dwordx4 v[144:147], v6, s[16:19], s7 offen sc1
    v_exp_f32 v180, v180
    v_mfma_f32_32x32x16_bf16 v[32:47], a[56:59], v[100:103], v[32:47]
    v_exp_f32 v165, v165
    v_exp_f32 v181, v181
    v_add_f32 v192, v152, v156
    v_add_f32 v193, v153, v157
    v_add_f32 v194, v154, v158
    v_mfma_f32_32x32x16_bf16 v[48:63], a[60:63], v[96:99], v[48:63]
    v_add_f32 v195, v155, v159
    v_add_f32 v196, v168, v172
    buffer_load_dwordx4 v[148:151], v7, s[16:19], s7 offen sc1
    v_add_f32 v197, v169, v173
    v_add_f32 v198, v170, v174
    v_mfma_f32_32x32x16_bf16 v[64:79], a[60:63], v[100:103], v[64:79]
    v_add_f32 v199, v171, v175
    v_add_f32 v192, v192, v160
    v_add_f32 v193, v193, v161
    v_add_f32 v194, v194, v162
    v_add_f32 v195, v195, v163
    v_add_f32 v196, v196, v176
    v_add_f32 v197, v197, v177
    s_waitcnt vmcnt(10)
    v_mfma_f32_32x32x16_bf16 v[16:31], a[64:67], v[104:107], v[16:31]
    s_cmp_gt_u32 s73, 14
    s_cselect_b32 s7, s5, s6
    s_add_u32 s7, s7, 28672
    buffer_load_dwordx4 v[96:99], v6, s[16:19], s7 offen sc1
    v_add_f32 v198, v198, v178
    v_add_f32 v199, v199, v179
    v_mfma_f32_32x32x16_bf16 v[32:47], a[64:67], v[108:111], v[32:47]
    v_add_f32 v192, v192, v164
    v_add_f32 v193, v193, v165
    v_add_f32 v194, v194, v195
    v_add_f32 v196, v196, v180
    v_add_f32 v197, v197, v181
    v_add_f32 v198, v198, v199
    v_add_f32 v192, v192, v193
    v_mfma_f32_32x32x16_bf16 v[48:63], a[68:71], v[104:107], v[48:63]
    buffer_load_dwordx4 v[100:103], v7, s[16:19], s7 offen sc1
    v_add_f32 v184, v192, v194
    v_add_f32 v188, v192, v194
    v_add_f32 v196, v196, v197
    v_add_f32 v186, v196, v198
    v_mfma_f32_32x32x16_bf16 v[64:79], a[68:71], v[108:111], v[64:79]
    v_add_f32 v189, v196, v198
    v_permlane32_swap_b32 v184, v188
    s_nop 0
    v_permlane32_swap_b32 v186, v189
    v_add_f32 v184, v184, v188
    v_add_f32 v186, v186, v189
    v_rcp_f32 v184, v184
    s_waitcnt vmcnt(10)
    v_mfma_f32_32x32x16_bf16 v[16:31], a[72:75], v[112:115], v[16:31]
    s_cmp_gt_u32 s73, 15
    s_cselect_b32 s7, s5, s6
    s_add_u32 s7, s7, 30720
    buffer_load_dwordx4 v[104:107], v6, s[16:19], s7 offen sc1
    v_rcp_f32 v186, v186
    v_mfma_f32_32x32x16_bf16 v[32:47], a[72:75], v[116:119], v[32:47]
    v_mul_f32 v152, v184, v152
    v_mul_f32 v153, v184, v153
    v_mul_f32 v154, v184, v154
    v_mul_f32 v155, v184, v155
    v_mul_f32 v156, v184, v156
    v_mul_f32 v157, v184, v157
    v_mul_f32 v158, v184, v158
    v_mfma_f32_32x32x16_bf16 v[48:63], a[76:79], v[112:115], v[48:63]
    v_mul_f32 v159, v184, v159
    buffer_load_dwordx4 v[108:111], v7, s[16:19], s7 offen sc1
    v_mul_f32 v160, v184, v160
    v_mul_f32 v161, v184, v161
    v_mul_f32 v162, v184, v162
    v_mfma_f32_32x32x16_bf16 v[64:79], a[76:79], v[116:119], v[64:79]
    v_mul_f32 v163, v184, v163
    v_mul_f32 v164, v184, v164
    v_mul_f32 v165, v184, v165
    v_mul_f32 v168, v186, v168
    v_mul_f32 v169, v186, v169
    v_mul_f32 v170, v186, v170
    v_mul_f32 v171, v186, v171
    s_waitcnt vmcnt(10)
    v_mfma_f32_32x32x16_bf16 v[16:31], a[80:83], v[120:123], v[16:31]
    s_cmp_gt_u32 s73, 16
    s_cselect_b32 s7, s5, s6
    s_add_u32 s7, s7, 32768
    buffer_load_dwordx4 v[112:115], v6, s[16:19], s7 offen sc1
    v_mul_f32 v172, v186, v172
    v_mul_f32 v173, v186, v173
    v_mfma_f32_32x32x16_bf16 v[32:47], a[80:83], v[124:127], v[32:47]
    v_mul_f32 v174, v186, v174
    v_mul_f32 v175, v186, v175
    v_mul_f32 v176, v186, v176
    v_mul_f32 v177, v186, v177
    v_mul_f32 v178, v186, v178
    v_mul_f32 v179, v186, v179
    v_mul_f32 v180, v186, v180
    v_mfma_f32_32x32x16_bf16 v[48:63], a[84:87], v[120:123], v[48:63]
    v_mul_f32 v181, v186, v181
    buffer_load_dwordx4 v[116:119], v7, s[16:19], s7 offen sc1
    v_cvt_pk_bf16_f32 v192, v152, v153
    v_cvt_pk_bf16_f32 v193, v154, v155
    v_cvt_pk_bf16_f32 v194, v156, v157
    v_mfma_f32_32x32x16_bf16 v[64:79], a[84:87], v[124:127], v[64:79]
    v_cvt_pk_bf16_f32 v195, v158, v159
    v_cvt_pk_bf16_f32 v196, v160, v161
    v_cvt_pk_bf16_f32 v197, v162, v163
    v_cvt_pk_bf16_f32 v198, v164, v165
    v_cvt_pk_bf16_f32 v200, v168, v169
    v_cvt_pk_bf16_f32 v201, v170, v171
    v_cvt_pk_bf16_f32 v202, v172, v173
    s_waitcnt vmcnt(10)
    v_mfma_f32_32x32x16_bf16 v[16:31], a[88:91], v[128:131], v[16:31]
    s_cmp_gt_u32 s73, 17
    s_cselect_b32 s7, s5, s6
    s_add_u32 s7, s7, 34816
    buffer_load_dwordx4 v[120:123], v6, s[16:19], s7 offen sc1
    v_cvt_pk_bf16_f32 v203, v174, v175
    v_cvt_pk_bf16_f32 v204, v176, v177
    v_mfma_f32_32x32x16_bf16 v[32:47], a[88:91], v[132:135], v[32:47]
    v_cvt_pk_bf16_f32 v205, v178, v179
    v_cvt_pk_bf16_f32 v206, v180, v181
    v_mov_b32 v199, 0
    v_mov_b32 v207, 0
    buffer_load_dwordx4 v[124:127], v7, s[16:19], s7 offen sc1
    v_mfma_f32_32x32x16_bf16 v[48:63], a[92:95], v[128:131], v[48:63]
    ds_write_b64 v11, v[192:193]
    v_xor_b32 v153, 16, v11
    ds_write_b64 v153, v[194:195]
    v_xor_b32 v154, 32, v11
    v_mfma_f32_32x32x16_bf16 v[64:79], a[92:95], v[132:135], v[64:79]
    ds_write_b64 v154, v[196:197]
    v_xor_b32 v155, 48, v11
    ds_write_b64 v155, v[198:199]
    s_waitcnt vmcnt(10)
    v_mfma_f32_32x32x16_bf16 v[16:31], a[96:99], v[136:139], v[16:31]
    s_cmp_gt_u32 s73, 18
    s_cselect_b32 s7, s5, s6
    s_add_u32 s7, s7, 36864
    buffer_load_dwordx4 v[128:131], v6, s[16:19], s7 offen sc1
    v_xor_b32 v156, 64, v11
    v_mfma_f32_32x32x16_bf16 v[32:47], a[96:99], v[140:143], v[32:47]
    ds_write_b64 v156, v[200:201]
    v_xor_b32 v157, 80, v11
    ds_write_b64 v157, v[202:203]
    v_xor_b32 v158, 96, v11
    v_mfma_f32_32x32x16_bf16 v[48:63], a[100:103], v[136:139], v[48:63]
    ds_write_b64 v158, v[204:205]
    buffer_load_dwordx4 v[132:135], v7, s[16:19], s7 offen sc1
    v_xor_b32 v159, 112, v11
    v_mfma_f32_32x32x16_bf16 v[64:79], a[100:103], v[140:143], v[64:79]
    ds_write_b64 v159, v[206:207]
    v_and_b32 v243, 1, v0
    v_lshlrev_b32 v243, 7, v243
    s_lshl_b32 s67, s55, 8
    s_add_u32 s67, s67, 32768
    s_waitcnt vmcnt(10)
    v_mfma_f32_32x32x16_bf16 v[16:31], a[104:107], v[144:147], v[16:31]
    s_cmp_gt_u32 s73, 19
    s_cselect_b32 s7, s5, s6
    s_add_u32 s7, s7, 38912
    buffer_load_dwordx4 v[136:139], v6, s[16:19], s7 offen sc1
    s_waitcnt lgkmcnt(0)
    s_barrier
    v_mfma_f32_32x32x16_bf16 v[32:47], a[104:107], v[148:151], v[32:47]
    ds_read_b64_tr_b16 v[152:153], v12 offset:0
    ds_read_b64_tr_b16 v[154:155], v13 offset:1024
    ds_read_b128 v[168:171], v15 offset:0
    ds_read_b64_tr_b16 v[156:157], v12 offset:2048
    v_mfma_f32_32x32x16_bf16 v[48:63], a[108:111], v[144:147], v[48:63]
    ds_read_b64_tr_b16 v[158:159], v13 offset:3072
    buffer_load_dwordx4 v[140:143], v7, s[16:19], s7 offen sc1
    ds_read_b128 v[172:175], v15 offset:1024
    ds_read_b64_tr_b16 v[160:161], v12 offset:4096
    ds_read_b64_tr_b16 v[162:163], v13 offset:5120
    v_mfma_f32_32x32x16_bf16 v[64:79], a[108:111], v[148:151], v[64:79]
    ds_read_b128 v[176:179], v15 offset:2048
    ds_read_b64_tr_b16 v[164:165], v12 offset:6144
    ds_read_b64_tr_b16 v[166:167], v13 offset:7168
    ds_read_b128 v[180:183], v15 offset:3072
    s_waitcnt vmcnt(10)
    v_mfma_f32_32x32x16_bf16 v[16:31], a[112:115], v[96:99], v[16:31]
    s_cmp_gt_u32 s73, 20
    s_cselect_b32 s7, s5, s6
    s_add_u32 s7, s7, 40960
    v_mfma_f32_32x32x16_bf16 v[32:47], a[112:115], v[100:103], v[32:47]
    buffer_load_dwordx4 v[144:147], v6, s[16:19], s7 offen sc1
    s_waitcnt lgkmcnt(9)
    v_mfma_f32_32x32x16_bf16 v[192:207], v[152:155], v[168:171], 0
    s_waitcnt lgkmcnt(6)
    v_mfma_f32_32x32x16_bf16 v[48:63], a[116:119], v[96:99], v[48:63]
    buffer_load_dwordx4 v[148:151], v7, s[16:19], s7 offen sc1
    v_mfma_f32_32x32x16_bf16 v[192:207], v[156:159], v[172:175], v[192:207]
    v_mfma_f32_32x32x16_bf16 v[64:79], a[116:119], v[100:103], v[64:79]
    s_waitcnt lgkmcnt(3)
    v_mfma_f32_32x32x16_bf16 v[192:207], v[160:163], v[176:179], v[192:207]
    s_waitcnt lgkmcnt(0)
    v_mfma_f32_32x32x16_bf16 v[192:207], v[164:167], v[180:183], v[192:207]
    s_waitcnt vmcnt(10)
    v_mfma_f32_32x32x16_bf16 v[16:31], a[120:123], v[104:107], v[16:31]
    s_cmp_gt_u32 s73, 21
    s_cselect_b32 s7, s5, s6
    s_add_u32 s7, s7, 43008
    buffer_load_dwordx4 v[96:99], v6, s[16:19], s7 offen sc1
    ds_read_b64_tr_b16 v[152:153], v12 offset:8192
    v_mfma_f32_32x32x16_bf16 v[32:47], a[120:123], v[108:111], v[32:47]
    ds_read_b64_tr_b16 v[154:155], v13 offset:9216
    ds_read_b128 v[168:171], v15 offset:4096
    ds_read_b64_tr_b16 v[156:157], v12 offset:10240
    ds_read_b64_tr_b16 v[158:159], v13 offset:11264
    v_mfma_f32_32x32x16_bf16 v[48:63], a[124:127], v[104:107], v[48:63]
    ds_read_b128 v[172:175], v15 offset:5120
    buffer_load_dwordx4 v[100:103], v7, s[16:19], s7 offen sc1
    ds_read_b64_tr_b16 v[160:161], v12 offset:12288
    ds_read_b64_tr_b16 v[162:163], v13 offset:13312
    v_mfma_f32_32x32x16_bf16 v[64:79], a[124:127], v[108:111], v[64:79]
    ds_read_b128 v[176:179], v15 offset:6144
    ds_read_b64_tr_b16 v[164:165], v12 offset:14336
    ds_read_b64_tr_b16 v[166:167], v13 offset:15360
    ds_read_b128 v[180:183], v15 offset:7168
    s_waitcnt vmcnt(10)
    v_mfma_f32_32x32x16_bf16 v[16:31], a[128:131], v[112:115], v[16:31]
    s_cmp_gt_u32 s73, 22
    s_cselect_b32 s7, s5, s6
    s_add_u32 s7, s7, 45056
    v_mfma_f32_32x32x16_bf16 v[32:47], a[128:131], v[116:119], v[32:47]
    buffer_load_dwordx4 v[104:107], v6, s[16:19], s7 offen sc1
    s_waitcnt lgkmcnt(9)
    v_mfma_f32_32x32x16_bf16 v[192:207], v[152:155], v[168:171], v[192:207]
    s_waitcnt lgkmcnt(6)
    v_mfma_f32_32x32x16_bf16 v[48:63], a[132:135], v[112:115], v[48:63]
    v_mfma_f32_32x32x16_bf16 v[192:207], v[156:159], v[172:175], v[192:207]
    buffer_load_dwordx4 v[108:111], v7, s[16:19], s7 offen sc1
    v_mfma_f32_32x32x16_bf16 v[64:79], a[132:135], v[116:119], v[64:79]
    s_waitcnt lgkmcnt(3)
    v_mfma_f32_32x32x16_bf16 v[192:207], v[160:163], v[176:179], v[192:207]
    s_waitcnt lgkmcnt(0)
    v_mfma_f32_32x32x16_bf16 v[192:207], v[164:167], v[180:183], v[192:207]
    s_waitcnt vmcnt(10)
    v_mfma_f32_32x32x16_bf16 v[16:31], a[136:139], v[120:123], v[16:31]
    s_cmp_gt_u32 s73, 23
    s_cselect_b32 s7, s5, s6
    s_add_u32 s7, s7, 47104
    buffer_load_dwordx4 v[112:115], v6, s[16:19], s7 offen sc1
    v_mfma_f32_32x32x16_bf16 v[32:47], a[136:139], v[124:127], v[32:47]
    v_max3_f32 v184, v208, v209, v210
    v_max3_f32 v185, v211, v212, v213
    v_min3_f32 v186, v208, v209, v210
    v_min3_f32 v187, v211, v212, v213
    v_max3_f32 v184, v184, v214, v215
    v_mfma_f32_32x32x16_bf16 v[48:63], a[140:143], v[120:123], v[48:63]
    v_max3_f32 v185, v185, v216, v217
    buffer_load_dwordx4 v[116:119], v7, s[16:19], s7 offen sc1
    v_min3_f32 v186, v186, v214, v215
    v_min3_f32 v187, v187, v216, v217
    v_mfma_f32_32x32x16_bf16 v[64:79], a[140:143], v[124:127], v[64:79]
    v_max3_f32 v184, v184, v218, v219
    v_max3_f32 v185, v185, v220, v221
    v_min3_f32 v186, v186, v218, v219
    v_min3_f32 v187, v187, v220, v221
    v_max_f32 v188, v184, v185
    s_waitcnt vmcnt(10)
    v_mfma_f32_32x32x16_bf16 v[16:31], a[144:147], v[128:131], v[16:31]
    s_cmp_gt_u32 s73, 24
    s_cselect_b32 s7, s5, s6
    s_add_u32 s7, s7, 49152
    buffer_load_dwordx4 v[120:123], v6, s[16:19], s7 offen sc1
    buffer_store_dwordx4 v[192:195], v1, s[44:47], s65 offen sc1
    v_mfma_f32_32x32x16_bf16 v[32:47], a[144:147], v[132:135], v[32:47]
    buffer_store_dwordx4 v[196:199], v1, s[44:47], s65 offen offset:1024 sc1
    v_max_f32 v184, v184, v185
    v_min_f32 v189, v186, v187
    v_min_f32 v186, v186, v187
    v_mfma_f32_32x32x16_bf16 v[48:63], a[148:151], v[128:131], v[48:63]
    v_mov_b32 v190, 0x3fb8aa3b
    v_permlane32_swap_b32 v184, v188
    v_permlane32_swap_b32 v186, v189
    buffer_load_dwordx4 v[124:127], v7, s[16:19], s7 offen sc1
    v_max_f32 v184, v184, v188
    v_mfma_f32_32x32x16_bf16 v[64:79], a[148:151], v[132:135], v[64:79]
    v_min_f32 v186, v186, v189
    v_mul_f32 v184, v190, v184
    v_mul_f32 v186, v190, v186
    v_fma_f32 v152, v208, v190, -v184
    v_fma_f32 v168, -v208, v190, v186
    v_fma_f32 v153, v209, v190, -v184
    s_waitcnt vmcnt(12)
    v_mfma_f32_32x32x16_bf16 v[16:31], a[152:155], v[136:139], v[16:31]
    s_cmp_gt_u32 s73, 25
    s_cselect_b32 s7, s5, s6
    s_add_u32 s7, s7, 51200
    buffer_load_dwordx4 v[128:131], v6, s[16:19], s7 offen sc1
    v_mfma_f32_32x32x16_bf16 v[32:47], a[152:155], v[140:143], v[32:47]
    v_fma_f32 v169, -v209, v190, v186
    v_exp_f32 v152, v152
    v_exp_f32 v168, v168
    v_mfma_f32_32x32x16_bf16 v[48:63], a[156:159], v[136:139], v[48:63]
    v_fma_f32 v154, v210, v190, -v184
    buffer_load_dwordx4 v[132:135], v7, s[16:19], s7 offen sc1
    v_fma_f32 v170, -v210, v190, v186
    v_exp_f32 v153, v153
    v_mfma_f32_32x32x16_bf16 v[64:79], a[156:159], v[140:143], v[64:79]
    v_exp_f32 v169, v169
    v_fma_f32 v155, v211, v190, -v184
    v_fma_f32 v171, -v211, v190, v186
    s_waitcnt vmcnt(12)
    v_mfma_f32_32x32x16_bf16 v[16:31], a[160:163], v[144:147], v[16:31]
    s_cmp_gt_u32 s73, 26
    s_cselect_b32 s7, s5, s6
    s_add_u32 s7, s7, 53248
    buffer_load_dwordx4 v[136:139], v6, s[16:19], s7 offen sc1
    v_mfma_f32_32x32x16_bf16 v[32:47], a[160:163], v[148:151], v[32:47]
    v_exp_f32 v154, v154
    v_exp_f32 v170, v170
    v_fma_f32 v156, v212, v190, -v184
    v_fma_f32 v172, -v212, v190, v186
    v_mfma_f32_32x32x16_bf16 v[48:63], a[164:167], v[144:147], v[48:63]
    buffer_load_dwordx4 v[140:143], v7, s[16:19], s7 offen sc1
    v_exp_f32 v155, v155
    v_mfma_f32_32x32x16_bf16 v[64:79], a[164:167], v[148:151], v[64:79]
    v_exp_f32 v171, v171
    v_fma_f32 v157, v213, v190, -v184
    v_fma_f32 v173, -v213, v190, v186
    v_exp_f32 v156, v156
    s_waitcnt vmcnt(12)
    v_mfma_f32_32x32x16_bf16 v[16:31], a[168:171], v[96:99], v[16:31]
    s_cmp_gt_u32 s73, 27
    s_cselect_b32 s7, s5, s6
    s_add_u32 s7, s7, 55296
    buffer_load_dwordx4 v[144:147], v6, s[16:19], s7 offen sc1
    v_mfma_f32_32x32x16_bf16 v[32:47], a[168:171], v[100:103], v[32:47]
    v_exp_f32 v172, v172
    v_fma_f32 v158, v214, v190, -v184
    v_fma_f32 v174, -v214, v190, v186
    v_exp_f32 v157, v157
    v_mfma_f32_32x32x16_bf16 v[48:63], a[172:175], v[96:99], v[48:63]
    buffer_load_dwordx4 v[148:151], v7, s[16:19], s7 offen sc1
    v_exp_f32 v173, v173
    v_fma_f32 v159, v215, v190, -v184
    v_mfma_f32_32x32x16_bf16 v[64:79], a[172:175], v[100:103], v[64:79]
    v_fma_f32 v175, -v215, v190, v186
    v_exp_f32 v158, v158
    v_exp_f32 v174, v174
    s_waitcnt vmcnt(12)
    v_mfma_f32_32x32x16_bf16 v[16:31], a[176:179], v[104:107], v[16:31]
    s_cmp_gt_u32 s73, 28
    s_cselect_b32 s7, s5, s6
    s_add_u32 s7, s7, 57344
    buffer_load_dwordx4 v[96:99], v6, s[16:19], s7 offen sc1
    v_mfma_f32_32x32x16_bf16 v[32:47], a[176:179], v[108:111], v[32:47]
    v_fma_f32 v160, v216, v190, -v184
    v_fma_f32 v176, -v216, v190, v186
    v_exp_f32 v159, v159
    v_exp_f32 v175, v175
    v_mfma_f32_32x32x16_bf16 v[48:63], a[180:183], v[104:107], v[48:63]
    buffer_load_dwordx4 v[100:103], v7, s[16:19], s7 offen sc1
    v_fma_f32 v161, v217, v190, -v184
    v_fma_f32 v177, -v217, v190, v186
    v_mfma_f32_32x32x16_bf16 v[64:79], a[180:183], v[108:111], v[64:79]
    v_exp_f32 v160, v160
    v_exp_f32 v176, v176
    v_fma_f32 v162, v218, v190, -v184
    s_waitcnt vmcnt(12)
    v_mfma_f32_32x32x16_bf16 v[16:31], a[184:187], v[112:115], v[16:31]
    s_cmp_gt_u32 s73, 29
    s_cselect_b32 s7, s5, s6
    s_add_u32 s7, s7, 59392
    buffer_load_dwordx4 v[104:107], v6, s[16:19], s7 offen sc1
    v_fma_f32 v178, -v218, v190, v186
    v_exp_f32 v161, v161
    v_mfma_f32_32x32x16_bf16 v[32:47], a[184:187], v[116:119], v[32:47]
    v_exp_f32 v177, v177
    v_fma_f32 v163, v219, v190, -v184
    v_fma_f32 v179, -v219, v190, v186
    buffer_load_dwordx4 v[108:111], v7, s[16:19], s7 offen sc1
    v_mfma_f32_32x32x16_bf16 v[48:63], a[188:191], v[112:115], v[48:63]
    v_exp_f32 v162, v162
    v_exp_f32 v178, v178
    v_fma_f32 v164, v220, v190, -v184
    v_fma_f32 v180, -v220, v190, v186
    v_mfma_f32_32x32x16_bf16 v[64:79], a[188:191], v[116:119], v[64:79]
    s_waitcnt vmcnt(11)
    s_barrier
    s_cmp_lg_u32 s48, 0
    s_cbranch_scc1 L_wf_11
    v_mov_b32 v249, s51
    v_mov_b32 v248, 0
    s_mov_b64 exec, 1
    buffer_store_dword v249, v248, s[44:47], s64 offen sc1
    s_mov_b64 exec, -1
L_wf_11:
    s_or_b32 s69, s2, s48
    s_cmp_lg_u32 s69, 0
    s_cbranch_scc1 L_noep
    s_mov_b32 s69, 16384
    v_mov_b32 v249, s51
    v_mov_b32 v248, 0
    s_mov_b64 exec, 1
    buffer_store_dword v249, v248, s[44:47], s69 offen sc1
    s_mov_b64 exec, -1
L_noep:
    s_waitcnt vmcnt(10)
    v_mfma_f32_32x32x16_bf16 v[16:31], a[192:195], v[120:123], v[16:31]
    s_cmp_gt_u32 s73, 30
    s_cselect_b32 s7, s5, s6
    s_add_u32 s7, s7, 61440
    buffer_load_dwordx4 v[112:115], v6, s[16:19], s7 offen sc1
    v_mfma_f32_32x32x16_bf16 v[32:47], a[192:195], v[124:127], v[32:47]
    v_exp_f32 v163, v163
    v_exp_f32 v179, v179
    v_fma_f32 v165, v221, v190, -v184
    v_fma_f32 v181, -v221, v190, v186
    v_mfma_f32_32x32x16_bf16 v[48:63], a[196:199], v[120:123], v[48:63]
    buffer_load_dwordx4 v[116:119], v7, s[16:19], s7 offen sc1
    v_exp_f32 v164, v164
    v_mfma_f32_32x32x16_bf16 v[64:79], a[196:199], v[124:127], v[64:79]
    v_exp_f32 v180, v180
    v_exp_f32 v165, v165
    v_exp_f32 v181, v181
    s_waitcnt vmcnt(10)
    v_mfma_f32_32x32x16_bf16 v[16:31], a[200:203], v[128:131], v[16:31]
    s_cmp_gt_u32 s73, 31
    s_cselect_b32 s7, s5, s6
    s_add_u32 s7, s7, 63488
    buffer_load_dwordx4 v[120:123], v6, s[16:19], s7 offen sc1
    v_mfma_f32_32x32x16_bf16 v[32:47], a[200:203], v[132:135], v[32:47]
    v_cvt_pk_bf16_f32 v208, v152, v153
    v_cvt_pk_bf16_f32 v209, v154, v155
    v_cvt_pk_bf16_f32 v210, v156, v157
    v_cvt_pk_bf16_f32 v211, v158, v159
    v_cvt_pk_bf16_f32 v212, v160, v161
    v_mfma_f32_32x32x16_bf16 v[48:63], a[204:207], v[128:131], v[48:63]
    v_cvt_pk_bf16_f32 v213, v162, v163
    buffer_load_dwordx4 v[124:127], v7, s[16:19], s7 offen sc1
    v_cvt_pk_bf16_f32 v214, v164, v165
    v_cvt_pk_bf16_f32 v216, v168, v169
    v_mfma_f32_32x32x16_bf16 v[64:79], a[204:207], v[132:135], v[64:79]
    v_cvt_pk_bf16_f32 v217, v170, v171
    v_cvt_pk_bf16_f32 v218, v172, v173
    v_cvt_pk_bf16_f32 v219, v174, v175
    v_cvt_pk_bf16_f32 v220, v176, v177
    v_cvt_pk_bf16_f32 v221, v178, v179
    s_waitcnt vmcnt(10)
    v_mfma_f32_32x32x16_bf16 v[16:31], a[208:211], v[136:139], v[16:31]
    v_cvt_pk_bf16_f32 v222, v180, v181
    v_mul_u32_u24 v2, 4096, v8
    v_add_u32 v2, v2, v9
    v_add_u32 v3, 31744, v2
    s_mul_i32 s68, s48, 1835008
    v_mfma_f32_32x32x16_bf16 v[32:47], a[208:211], v[140:143], v[32:47]
    s_lshl_b32 s69, s57, 7
    s_add_u32 s68, s68, s69
    s_mul_i32 s4, s58, 4
    s_sub_u32 s4, 28, s4
    s_mul_i32 s1, s58, 262144
    s_add_u32 s1, s1, s68
    v_mfma_f32_32x32x16_bf16 v[48:63], a[212:215], v[136:139], v[48:63]
    s_sub_u32 s3, s1, 1835008
    s_add_u32 m0, s72, 16384
    s_cmp_gt_u32 s4, 0
    s_cselect_b32 s75, s1, s3
    v_mfma_f32_32x32x16_bf16 v[64:79], a[212:215], v[140:143], v[64:79]
    buffer_load_dwordx4 v2, s[32:35], s75 offen lds
    v_mov_b32 v215, 0
    v_mov_b32 v223, 0
    buffer_load_dwordx4 v3, s[32:35], s75 offen offset:1024 lds
    s_waitcnt vmcnt(10)
    v_mfma_f32_32x32x16_bf16 v[16:31], a[216:219], v[144:147], v[16:31]
    s_add_u32 m0, s72, 18432
    s_cmp_gt_u32 s4, 1
    v_mfma_f32_32x32x16_bf16 v[32:47], a[216:219], v[148:151], v[32:47]
    s_cselect_b32 s75, s1, s3
    s_add_u32 s75, s75, 65536
    v_mfma_f32_32x32x16_bf16 v[48:63], a[220:223], v[144:147], v[48:63]
    buffer_load_dwordx4 v2, s[32:35], s75 offen lds
    v_mfma_f32_32x32x16_bf16 v[64:79], a[220:223], v[148:151], v[64:79]
    buffer_load_dwordx4 v3, s[32:35], s75 offen offset:1024 lds
    s_waitcnt vmcnt(10)
    v_mfma_f32_32x32x16_bf16 v[64:79], a[228:231], v[100:103], v[64:79]
    s_xor_b32 s69, s48, 3
    s_mul_i32 s69, s69, 12288
    s_add_u32 s69, s69, 8192
    v_mfma_f32_32x32x16_bf16 v[48:63], a[228:231], v[96:99], v[48:63]
    v_add_u32 v14, s69, v1
    s_xor_b32 s69, s48, 2
    v_mfma_f32_32x32x16_bf16 v[32:47], a[224:227], v[100:103], v[32:47]
    s_mul_i32 s69, s69, 12288
    s_add_u32 s69, s69, 4096
    v_add_u32 v13, s69, v1
    s_waitcnt vmcnt(8)
    v_mfma_f32_32x32x16_bf16 v[64:79], a[236:239], v[108:111], v[64:79]
    s_xor_b32 s69, s48, 1
    s_mul_i32 s69, s69, 12288
    v_mfma_f32_32x32x16_bf16 v[48:63], a[236:239], v[104:107], v[48:63]
    v_add_u32 v12, s69, v1
    s_xor_b32 s69, s48, 0
    v_mfma_f32_32x32x16_bf16 v[32:47], a[232:235], v[108:111], v[32:47]
    s_mul_i32 s69, s69, 12288
    v_add_u32 v11, s69, v1
    s_waitcnt vmcnt(6)
    v_mfma_f32_32x32x16_bf16 v[64:79], a[244:247], v[116:119], v[64:79]
    s_add_u32 m0, s72, 20480
    s_cmp_gt_u32 s4, 2
    s_cselect_b32 s75, s1, s3
    v_mfma_f32_32x32x16_bf16 v[48:63], a[244:247], v[112:115], v[48:63]
    s_add_u32 s75, s75, 131072
    buffer_load_dwordx4 v2, s[32:35], s75 offen lds
    v_mfma_f32_32x32x16_bf16 v[32:47], a[240:243], v[116:119], v[32:47]
    buffer_load_dwordx4 v3, s[32:35], s75 offen offset:1024 lds
    s_waitcnt vmcnt(6)
    v_mfma_f32_32x32x16_bf16 v[64:79], a[252:255], v[124:127], v[64:79]
    s_add_u32 m0, s72, 22528
    s_cmp_gt_u32 s4, 3
    s_cselect_b32 s75, s1, s3
    v_mfma_f32_32x32x16_bf16 v[48:63], a[252:255], v[120:123], v[48:63]
    s_add_u32 s75, s75, 196608
    buffer_load_dwordx4 v2, s[32:35], s75 offen lds
    v_mfma_f32_32x32x16_bf16 v[32:47], a[248:251], v[124:127], v[32:47]
    buffer_load_dwordx4 v3, s[32:35], s75 offen offset:1024 lds
    v_mfma_f32_32x32x16_bf16 v[16:31], a[224:227], v[96:99], v[16:31]
    s_nop 2
    ds_write_b128 v14, v[64:67] offset:0
    ds_write_b128 v14, v[68:71] offset:1024
    ds_write_b128 v14, v[72:75] offset:2048
    v_mfma_f32_32x32x16_bf16 v[16:31], a[232:235], v[104:107], v[16:31]
    ds_write_b128 v14, v[76:79] offset:3072
    ds_write_b128 v13, v[48:51] offset:0
    ds_write_b128 v13, v[52:55] offset:1024
    v_mfma_f32_32x32x16_bf16 v[16:31], a[240:243], v[112:115], v[16:31]
    ds_write_b128 v13, v[56:59] offset:2048
    ds_write_b128 v13, v[60:63] offset:3072
    ds_write_b128 v12, v[32:35] offset:0
    v_mfma_f32_32x32x16_bf16 v[16:31], a[248:251], v[120:123], v[16:31]
    ds_write_b128 v12, v[36:39] offset:1024
    ds_write_b128 v12, v[40:43] offset:2048
    ds_write_b128 v12, v[44:47] offset:3072
    s_add_u32 m0, s72, 0
    s_cmp_gt_u32 s4, 4
    s_cselect_b32 s75, s1, s3
    s_add_u32 s75, s75, 262144
    buffer_load_dwordx4 v2, s[32:35], s75 offen lds
    buffer_load_dwordx4 v3, s[32:35], s75 offen offset:1024 lds
    s_add_u32 m0, s72, 2048
    s_cmp_gt_u32 s4, 5
    s_cselect_b32 s75, s1, s3
    s_add_u32 s75, s75, 327680
    buffer_load_dwordx4 v2, s[32:35], s75 offen lds
    buffer_load_dwordx4 v3, s[32:35], s75 offen offset:1024 lds
    s_waitcnt lgkmcnt(0)
    s_barrier
    ds_read_b128 v[96:99], v11 offset:0
    ds_read_b128 v[100:103], v11 offset:1024
    ds_read_b128 v[104:107], v11 offset:2048
    ds_read_b128 v[108:111], v11 offset:3072
    ds_read_b128 v[112:115], v11 offset:4096
    ds_read_b128 v[116:119], v11 offset:5120
    ds_read_b128 v[120:123], v11 offset:6144
    ds_read_b128 v[124:127], v11 offset:7168
    ds_read_b128 v[128:131], v11 offset:8192
    ds_read_b128 v[132:135], v11 offset:9216
    ds_read_b128 v[136:139], v11 offset:10240
    ds_read_b128 v[140:143], v11 offset:11264
    v_mov_b32 v12, 0xc0135761
    v_mov_b32 v14, 0xbdd2d3e8
    s_mul_i32 s65, s53, 112
    s_lshl_b32 s66, s52, 2
    s_add_u32 s65, s65, s66
    s_and_b32 s66, s48, 2
    s_add_u32 s65, s65, s66
    s_lshl_b32 s65, s65, 1
    s_and_b32 s66, s48, 1
    s_add_u32 s65, s65, s66
    s_lshl_b32 s65, s65, 10
    s_add_u32 s65, s65, 7340032
    s_lshl_b32 s64, s53, 5
    s_add_u32 s64, s64, s52
    s_lshl_b32 s64, s64, 7
    s_add_u32 s64, s64, 327680
    s_add_u32 m0, s72, 4096
    s_cmp_gt_u32 s4, 6
    s_cselect_b32 s75, s1, s3
    s_add_u32 s75, s75, 393216
    buffer_load_dwordx4 v2, s[32:35], s75 offen lds
    buffer_load_dwordx4 v3, s[32:35], s75 offen offset:1024 lds
    s_add_u32 m0, s72, 6144
    s_cmp_gt_u32 s4, 7
    s_cselect_b32 s75, s1, s3
    s_add_u32 s75, s75, 458752
    buffer_load_dwordx4 v2, s[32:35], s75 offen lds
    buffer_load_dwordx4 v3, s[32:35], s75 offen offset:1024 lds
    s_waitcnt lgkmcnt(8)
.p2align 3
    v_pk_add_f32 v[16:17], v[16:17], v[96:97]
    v_pk_add_f32 v[18:19], v[18:19], v[98:99]
    v_pk_add_f32 v[20:21], v[20:21], v[100:101]
    v_pk_add_f32 v[22:23], v[22:23], v[102:103]
    v_pk_add_f32 v[24:25], v[24:25], v[104:105]
    v_pk_add_f32 v[26:27], v[26:27], v[106:107]
    v_pk_add_f32 v[28:29], v[28:29], v[108:109]
    v_pk_add_f32 v[30:31], v[30:31], v[110:111]
    s_waitcnt lgkmcnt(4)
.p2align 3
    v_pk_add_f32 v[16:17], v[16:17], v[112:113]
    v_pk_add_f32 v[18:19], v[18:19], v[114:115]
    v_pk_add_f32 v[20:21], v[20:21], v[116:117]
    v_pk_add_f32 v[22:23], v[22:23], v[118:119]
    v_pk_add_f32 v[24:25], v[24:25], v[120:121]
    v_pk_add_f32 v[26:27], v[26:27], v[122:123]
    v_pk_add_f32 v[28:29], v[28:29], v[124:125]
    v_pk_add_f32 v[30:31], v[30:31], v[126:127]
    s_waitcnt lgkmcnt(0)
.p2align 3
    v_pk_add_f32 v[16:17], v[16:17], v[128:129]
    v_pk_add_f32 v[18:19], v[18:19], v[130:131]
    v_pk_add_f32 v[20:21], v[20:21], v[132:133]
    v_pk_add_f32 v[22:23], v[22:23], v[134:135]
    v_pk_add_f32 v[24:25], v[24:25], v[136:137]
    v_pk_add_f32 v[26:27], v[26:27], v[138:139]
    v_pk_add_f32 v[28:29], v[28:29], v[140:141]
    v_pk_add_f32 v[30:31], v[30:31], v[142:143]
.p2align 3
    v_pk_mul_f32 v[32:33], v[16:17], v[16:17]
    v_pk_mul_f32 v[34:35], v[18:19], v[18:19]
    v_pk_mul_f32 v[36:37], v[20:21], v[20:21]
    v_pk_mul_f32 v[38:39], v[22:23], v[22:23]
    v_pk_mul_f32 v[40:41], v[24:25], v[24:25]
    v_pk_mul_f32 v[42:43], v[26:27], v[26:27]
    v_pk_mul_f32 v[44:45], v[28:29], v[28:29]
    v_pk_mul_f32 v[46:47], v[30:31], v[30:31]
    v_pk_fma_f32 v[32:33], v[32:33], v[14:15], v[12:13] op_sel_hi:[1,0,0]
    s_add_u32 m0, s72, 8192
    s_cmp_gt_u32 s4, 8
    s_cselect_b32 s75, s1, s3
    s_add_u32 s75, s75, 524288
    buffer_load_dwordx4 v2, s[32:35], s75 offen lds
    v_lshl_add_u32 v4, v240, 9, v10
    s_lshr_b32 s69, s48, 0
    s_and_b32 s69, s69, 1
    s_lshl_b32 s69, s69, 6
    v_xor_b32 v4, s69, v4
    v_xor_b32 v5, 64, v4
    s_waitcnt vmcnt(15)
    ds_read_b64_tr_b16 a[0:1], v4 offset:16384
    ds_read_b64_tr_b16 a[2:3], v4 offset:17408
    v_pk_fma_f32 v[34:35], v[34:35], v[14:15], v[12:13] op_sel_hi:[1,0,0]
    v_pk_fma_f32 v[36:37], v[36:37], v[14:15], v[12:13] op_sel_hi:[1,0,0]
    v_pk_fma_f32 v[38:39], v[38:39], v[14:15], v[12:13] op_sel_hi:[1,0,0]
    v_pk_fma_f32 v[40:41], v[40:41], v[14:15], v[12:13] op_sel_hi:[1,0,0]
    v_pk_fma_f32 v[42:43], v[42:43], v[14:15], v[12:13] op_sel_hi:[1,0,0]
    buffer_load_dwordx4 v3, s[32:35], s75 offen offset:1024 lds
    ds_read_b64_tr_b16 a[4:5], v5 offset:16384
    ds_read_b64_tr_b16 a[6:7], v5 offset:17408
    v_pk_fma_f32 v[44:45], v[44:45], v[14:15], v[12:13] op_sel_hi:[1,0,0]
    v_pk_fma_f32 v[46:47], v[46:47], v[14:15], v[12:13] op_sel_hi:[1,0,0]
    v_pk_mul_f32 v[32:33], v[32:33], v[16:17]
    v_pk_mul_f32 v[34:35], v[34:35], v[18:19]
    v_pk_mul_f32 v[36:37], v[36:37], v[20:21]
    v_pk_mul_f32 v[38:39], v[38:39], v[22:23]
    v_pk_mul_f32 v[40:41], v[40:41], v[24:25]
    v_pk_mul_f32 v[42:43], v[42:43], v[26:27]
    s_add_u32 m0, s72, 10240
    s_cmp_gt_u32 s4, 9
    s_cselect_b32 s75, s1, s3
    s_add_u32 s75, s75, 589824
    buffer_load_dwordx4 v2, s[32:35], s75 offen lds
    s_waitcnt vmcnt(15)
    ds_read_b64_tr_b16 a[8:9], v4 offset:18432
    ds_read_b64_tr_b16 a[10:11], v4 offset:19456
    v_pk_mul_f32 v[44:45], v[44:45], v[28:29]
    v_pk_mul_f32 v[46:47], v[46:47], v[30:31]
    v_exp_f32 v32, v32
    v_exp_f32 v33, v33
    v_exp_f32 v34, v34
    v_exp_f32 v35, v35
    buffer_load_dwordx4 v3, s[32:35], s75 offen offset:1024 lds
    ds_read_b64_tr_b16 a[12:13], v5 offset:18432
    ds_read_b64_tr_b16 a[14:15], v5 offset:19456
    v_exp_f32 v36, v36
    v_exp_f32 v37, v37
    v_exp_f32 v38, v38
    v_exp_f32 v39, v39
    v_exp_f32 v40, v40
    s_add_u32 m0, s72, 12288
    s_cmp_gt_u32 s4, 10
    s_cselect_b32 s75, s1, s3
    s_add_u32 s75, s75, 655360
    buffer_load_dwordx4 v2, s[32:35], s75 offen lds
    s_waitcnt vmcnt(15)
    ds_read_b64_tr_b16 a[16:17], v4 offset:20480
    ds_read_b64_tr_b16 a[18:19], v4 offset:21504
    v_exp_f32 v41, v41
    v_exp_f32 v42, v42
    v_exp_f32 v43, v43
    v_exp_f32 v44, v44
    v_exp_f32 v45, v45
    buffer_load_dwordx4 v3, s[32:35], s75 offen offset:1024 lds
    ds_read_b64_tr_b16 a[20:21], v5 offset:20480
    ds_read_b64_tr_b16 a[22:23], v5 offset:21504
    v_exp_f32 v46, v46
    v_exp_f32 v47, v47
    v_add_f32 v32, 1.0, v32
    v_add_f32 v33, 1.0, v33
    v_add_f32 v34, 1.0, v34
    v_add_f32 v35, 1.0, v35
    v_add_f32 v36, 1.0, v36
    v_add_f32 v37, 1.0, v37
    s_add_u32 m0, s72, 14336
    s_cmp_gt_u32 s4, 11
    s_cselect_b32 s75, s1, s3
    s_add_u32 s75, s75, 720896
    buffer_load_dwordx4 v2, s[32:35], s75 offen lds
    s_waitcnt vmcnt(15)
    ds_read_b64_tr_b16 a[24:25], v4 offset:22528
    ds_read_b64_tr_b16 a[26:27], v4 offset:23552
    v_add_f32 v38, 1.0, v38
    v_add_f32 v39, 1.0, v39
    v_add_f32 v40, 1.0, v40
    v_add_f32 v41, 1.0, v41
    v_add_f32 v42, 1.0, v42
    v_add_f32 v43, 1.0, v43
    v_add_f32 v44, 1.0, v44
    v_add_f32 v45, 1.0, v45
    v_add_f32 v46, 1.0, v46
    v_add_f32 v47, 1.0, v47
    buffer_load_dwordx4 v3, s[32:35], s75 offen offset:1024 lds
    ds_read_b64_tr_b16 a[28:29], v5 offset:22528
    ds_read_b64_tr_b16 a[30:31], v5 offset:23552
    v_rcp_f32 v32, v32
    v_rcp_f32 v33, v33
    v_rcp_f32 v34, v34
    v_rcp_f32 v35, v35
    v_rcp_f32 v36, v36
    s_waitcnt lgkmcnt(12)
    s_add_u32 m0, s72, 16384
    s_cmp_gt_u32 s4, 12
    s_cselect_b32 s75, s1, s3
    s_add_u32 s75, s75, 786432
    buffer_load_dwordx4 v2, s[32:35], s75 offen lds
    s_waitcnt vmcnt(15)
    ds_read_b64_tr_b16 a[32:33], v4 offset:0
    ds_read_b64_tr_b16 a[34:35], v4 offset:1024
    v_rcp_f32 v37, v37
    v_rcp_f32 v38, v38
    v_rcp_f32 v39, v39
    v_rcp_f32 v40, v40
    v_rcp_f32 v41, v41
    buffer_load_dwordx4 v3, s[32:35], s75 offen offset:1024 lds
    ds_read_b64_tr_b16 a[36:37], v5 offset:0
    ds_read_b64_tr_b16 a[38:39], v5 offset:1024
    v_rcp_f32 v42, v42
    v_rcp_f32 v43, v43
    v_rcp_f32 v44, v44
    v_rcp_f32 v45, v45
    v_rcp_f32 v46, v46
    s_waitcnt lgkmcnt(12)
    s_add_u32 m0, s72, 18432
    s_cmp_gt_u32 s4, 13
    s_cselect_b32 s75, s1, s3
    s_add_u32 s75, s75, 851968
    buffer_load_dwordx4 v2, s[32:35], s75 offen lds
    s_waitcnt vmcnt(15)
    ds_read_b64_tr_b16 a[40:41], v4 offset:2048
    ds_read_b64_tr_b16 a[42:43], v4 offset:3072
    v_rcp_f32 v47, v47
.p2align 3
    v_pk_mul_f32 v[16:17], v[16:17], v[32:33]
    v_pk_mul_f32 v[18:19], v[18:19], v[34:35]
    v_pk_mul_f32 v[20:21], v[20:21], v[36:37]
    v_pk_mul_f32 v[22:23], v[22:23], v[38:39]
    v_pk_mul_f32 v[24:25], v[24:25], v[40:41]
    v_pk_mul_f32 v[26:27], v[26:27], v[42:43]
    v_pk_mul_f32 v[28:29], v[28:29], v[44:45]
    v_pk_mul_f32 v[30:31], v[30:31], v[46:47]
    buffer_load_dwordx4 v3, s[32:35], s75 offen offset:1024 lds
    ds_read_b64_tr_b16 a[44:45], v5 offset:2048
    ds_read_b64_tr_b16 a[46:47], v5 offset:3072
.p2align 3
    v_cvt_pk_bf16_f32 v88, v16, v17
    v_cvt_pk_bf16_f32 v89, v18, v19
    v_cvt_pk_bf16_f32 v90, v20, v21
    v_cvt_pk_bf16_f32 v91, v22, v23
    v_cvt_pk_bf16_f32 v92, v24, v25
    v_cvt_pk_bf16_f32 v93, v26, v27
    v_cvt_pk_bf16_f32 v94, v28, v29
    v_cvt_pk_bf16_f32 v95, v30, v31
    buffer_store_dwordx4 v[88:91], v1, s[44:47], s65 offen sc1
    buffer_store_dwordx4 v[92:95], v1, s[44:47], s65 offen offset:2048 sc1
    s_waitcnt lgkmcnt(12)
    s_add_u32 m0, s72, 20480
    s_cmp_gt_u32 s4, 14
    s_cselect_b32 s75, s1, s3
    s_add_u32 s75, s75, 917504
    buffer_load_dwordx4 v2, s[32:35], s75 offen lds
    s_waitcnt vmcnt(17)
    ds_read_b64_tr_b16 a[48:49], v4 offset:4096
    ds_read_b64_tr_b16 a[50:51], v4 offset:5120
    buffer_load_dwordx4 v3, s[32:35], s75 offen offset:1024 lds
    ds_read_b64_tr_b16 a[52:53], v5 offset:4096
    ds_read_b64_tr_b16 a[54:55], v5 offset:5120
    v_min_u32 v245, 6, v0
    v_lshlrev_b32 v245, 7, v245
    v_and_b32 v246, 3, v0
    v_lshlrev_b32 v246, 7, v246
    s_lshl_b32 s62, s58, 5
    s_mul_i32 s66, s48, 7
    s_add_u32 s62, s62, s66
    s_lshl_b32 s62, s62, 7
    s_add_u32 s62, s62, 327680
    s_and_b32 s63, s48, 1
    s_lshl_b32 s60, s57, 1
    s_add_u32 s60, s60, s63
    s_lshl_b32 s60, s60, 5
    s_lshl_b32 s61, s60, 1
    s_mul_i32 s60, s60, 896
    s_lshr_b32 s66, s48, 1
    s_lshl_b32 s63, s58, 1
    s_add_u32 s63, s63, s66
    s_lshl_b32 s63, s63, 6
    s_add_u32 s60, s60, s63
    v_lshlrev_b32 v247, 1, v241
    v_mul_u32_u24 v244, 896, v241
    v_lshl_add_u32 v244, v240, 4, v244
    buffer_load_dwordx4 v[224:227], v244, s[8:11], s60 offen offset:0
    buffer_load_dwordx4 v[228:231], v244, s[8:11], s60 offen offset:32
    buffer_load_ushort v232, v247, s[36:39], s61 offen
    s_waitcnt lgkmcnt(12)
    s_add_u32 m0, s72, 22528
    s_cmp_gt_u32 s4, 15
    s_cselect_b32 s75, s1, s3
    s_add_u32 s75, s75, 983040
    buffer_load_dwordx4 v2, s[32:35], s75 offen lds
    s_waitcnt vmcnt(20)
    ds_read_b64_tr_b16 a[56:57], v4 offset:6144
    ds_read_b64_tr_b16 a[58:59], v4 offset:7168
    buffer_load_dwordx4 v3, s[32:35], s75 offen offset:1024 lds
    ds_read_b64_tr_b16 a[60:61], v5 offset:6144
    ds_read_b64_tr_b16 a[62:63], v5 offset:7168
    s_waitcnt lgkmcnt(12)
    s_add_u32 m0, s72, 0
    s_cmp_gt_u32 s4, 16
    s_cselect_b32 s75, s1, s3
    s_add_u32 s75, s75, 1048576
    buffer_load_dwordx4 v2, s[32:35], s75 offen lds
    s_waitcnt vmcnt(20)
    ds_read_b64_tr_b16 a[64:65], v4 offset:8192
    ds_read_b64_tr_b16 a[66:67], v4 offset:9216
    buffer_load_dwordx4 v3, s[32:35], s75 offen offset:1024 lds
    ds_read_b64_tr_b16 a[68:69], v5 offset:8192
    ds_read_b64_tr_b16 a[70:71], v5 offset:9216
    s_waitcnt lgkmcnt(12)
    s_add_u32 m0, s72, 2048
    s_cmp_gt_u32 s4, 17
    s_cselect_b32 s75, s1, s3
    s_add_u32 s75, s75, 1114112
    buffer_load_dwordx4 v2, s[32:35], s75 offen lds
    s_waitcnt vmcnt(20)
    ds_read_b64_tr_b16 a[72:73], v4 offset:10240
    ds_read_b64_tr_b16 a[74:75], v4 offset:11264
    buffer_load_dwordx4 v3, s[32:35], s75 offen offset:1024 lds
    ds_read_b64_tr_b16 a[76:77], v5 offset:10240
    ds_read_b64_tr_b16 a[78:79], v5 offset:11264
    s_waitcnt lgkmcnt(12)
    s_add_u32 m0, s72, 4096
    s_cmp_gt_u32 s4, 18
    s_cselect_b32 s75, s1, s3
    s_add_u32 s75, s75, 1179648
    buffer_load_dwordx4 v2, s[32:35], s75 offen lds
    s_waitcnt vmcnt(20)
    ds_read_b64_tr_b16 a[80:81], v4 offset:12288
    ds_read_b64_tr_b16 a[82:83], v4 offset:13312
    buffer_load_dwordx4 v3, s[32:35], s75 offen offset:1024 lds
    ds_read_b64_tr_b16 a[84:85], v5 offset:12288
    ds_read_b64_tr_b16 a[86:87], v5 offset:13312
    s_waitcnt lgkmcnt(12)
    s_add_u32 m0, s72, 6144
    s_cmp_gt_u32 s4, 19
    s_cselect_b32 s75, s1, s3
    s_add_u32 s75, s75, 1245184
    buffer_load_dwordx4 v2, s[32:35], s75 offen lds
    s_waitcnt vmcnt(20)
    ds_read_b64_tr_b16 a[88:89], v4 offset:14336
    ds_read_b64_tr_b16 a[90:91], v4 offset:15360
    buffer_load_dwordx4 v3, s[32:35], s75 offen offset:1024 lds
    ds_read_b64_tr_b16 a[92:93], v5 offset:14336
    ds_read_b64_tr_b16 a[94:95], v5 offset:15360
    s_waitcnt vmcnt(15)
    s_barrier
    s_cmp_lg_u32 s48, 0
    s_cbranch_scc1 L_wf_12
    v_mov_b32 v249, s51
    v_mov_b32 v248, 0
    s_mov_b64 exec, 1
    buffer_store_dword v249, v248, s[44:47], s64 offen sc1
    s_mov_b64 exec, -1
L_wf_12:
    s_lshl_b32 s61, s55, 12
    s_add_u32 s61, s61, 65536
    s_lshl_b32 s65, s56, 1
    s_lshr_b32 s66, s48, 1
    s_add_u32 s65, s65, s66
    s_lshl_b32 s65, s65, 4
    s_add_u32 s65, s65, s55
    s_lshl_b32 s65, s65, 2
    s_and_b32 s66, s48, 1
    s_add_u32 s65, s65, s66
    s_lshl_b32 s65, s65, 10
    s_add_u32 s65, s65, 9437184
    s_lshl_b32 s64, s56, 4
    s_add_u32 s64, s64, s55
    s_lshl_b32 s64, s64, 7
    s_add_u32 s64, s64, 393216
    s_lshr_b32 s69, s48, 1
    s_and_b32 s69, s69, 1
    s_lshl_b32 s69, s69, 10
    v_add_u32 v6, s69, v1
    v_xor_b32 v7, 0x400, v6
    s_mul_i32 s63, s58, 112
    s_mul_i32 s66, s48, 28
    s_add_u32 s63, s63, s66
    s_lshl_b32 s63, s63, 11
    s_add_u32 s63, s63, 7340032
    s_mul_i32 s73, s58, 4
    s_sub_u32 s73, 28, s73
    s_mul_i32 s5, s58, 8192
    s_add_u32 s5, s5, s63
    s_sub_u32 s6, s5, 57344
    s_lshl_b32 s63, s57, 2
    s_add_u32 s63, s63, s48
    s_lshl_b32 s63, s63, 14
    s_add_u32 s63, s63, 9437184
    s_lshr_b32 s66, s57, 1
    s_lshl_b32 s66, s66, 2
    s_add_u32 s66, s66, s48
    s_lshl_b32 s66, s66, 9
    s_add_u32 s66, s66, 393216
    s_waitcnt lgkmcnt(12)
    s_add_u32 m0, s72, 8192
    s_cmp_gt_u32 s4, 20
    s_cselect_b32 s75, s1, s3
    s_add_u32 s75, s75, 1310720
    buffer_load_dwordx4 v2, s[32:35], s75 offen lds
    ds_read_b64_tr_b16 a[96:97], v4 offset:16384
    ds_read_b64_tr_b16 a[98:99], v4 offset:17408
    buffer_load_dwordx4 v3, s[32:35], s75 offen offset:1024 lds
    ds_read_b64_tr_b16 a[100:101], v5 offset:16384
    ds_read_b64_tr_b16 a[102:103], v5 offset:17408
    s_waitcnt lgkmcnt(12)
    s_add_u32 m0, s72, 10240
    s_cmp_gt_u32 s4, 21
    s_cselect_b32 s75, s1, s3
    s_add_u32 s75, s75, 1376256
    buffer_load_dwordx4 v2, s[32:35], s75 offen lds
    ds_read_b64_tr_b16 a[104:105], v4 offset:18432
    ds_read_b64_tr_b16 a[106:107], v4 offset:19456
    buffer_load_dwordx4 v3, s[32:35], s75 offen offset:1024 lds
    ds_read_b64_tr_b16 a[108:109], v5 offset:18432
    ds_read_b64_tr_b16 a[110:111], v5 offset:19456
    s_waitcnt lgkmcnt(12)
    s_add_u32 m0, s72, 12288
    s_cmp_gt_u32 s4, 22
    s_cselect_b32 s75, s1, s3
    s_add_u32 s75, s75, 1441792
    buffer_load_dwordx4 v2, s[32:35], s75 offen lds
    s_waitcnt vmcnt(18)
    ds_read_b64_tr_b16 a[112:113], v4 offset:20480
    ds_read_b64_tr_b16 a[114:115], v4 offset:21504
    buffer_load_dwordx4 v3, s[32:35], s75 offen offset:1024 lds
    ds_read_b64_tr_b16 a[116:117], v5 offset:20480
    ds_read_b64_tr_b16 a[118:119], v5 offset:21504
    s_waitcnt lgkmcnt(12)
    s_add_u32 m0, s72, 14336
    s_cmp_gt_u32 s4, 23
    s_cselect_b32 s75, s1, s3
    s_add_u32 s75, s75, 1507328
    buffer_load_dwordx4 v2, s[32:35], s75 offen lds
    s_waitcnt vmcnt(15)
    ds_read_b64_tr_b16 a[120:121], v4 offset:22528
    ds_read_b64_tr_b16 a[122:123], v4 offset:23552
    buffer_load_dwordx4 v3, s[32:35], s75 offen offset:1024 lds
    ds_read_b64_tr_b16 a[124:125], v5 offset:22528
    ds_read_b64_tr_b16 a[126:127], v5 offset:23552
    s_waitcnt lgkmcnt(12)
    s_add_u32 m0, s72, 16384
    s_cmp_gt_u32 s4, 24
    s_cselect_b32 s75, s1, s3
    s_add_u32 s75, s75, 1572864
    buffer_load_dwordx4 v2, s[32:35], s75 offen lds
    s_waitcnt vmcnt(15)
    ds_read_b64_tr_b16 a[128:129], v4 offset:0
    ds_read_b64_tr_b16 a[130:131], v4 offset:1024
    buffer_load_dwordx4 v3, s[32:35], s75 offen offset:1024 lds
    ds_read_b64_tr_b16 a[132:133], v5 offset:0
    ds_read_b64_tr_b16 a[134:135], v5 offset:1024
    s_waitcnt lgkmcnt(12)
    s_add_u32 m0, s72, 18432
    s_cmp_gt_u32 s4, 25
    s_cselect_b32 s75, s1, s3
    s_add_u32 s75, s75, 1638400
    buffer_load_dwordx4 v2, s[32:35], s75 offen lds
    s_waitcnt vmcnt(15)
    ds_read_b64_tr_b16 a[136:137], v4 offset:2048
    ds_read_b64_tr_b16 a[138:139], v4 offset:3072
    buffer_load_dwordx4 v3, s[32:35], s75 offen offset:1024 lds
    ds_read_b64_tr_b16 a[140:141], v5 offset:2048
    ds_read_b64_tr_b16 a[142:143], v5 offset:3072
    s_waitcnt lgkmcnt(12)
    s_add_u32 m0, s72, 20480
    s_cmp_gt_u32 s4, 26
    s_cselect_b32 s75, s1, s3
    s_add_u32 s75, s75, 1703936
    buffer_load_dwordx4 v2, s[32:35], s75 offen lds
    s_waitcnt vmcnt(15)
    ds_read_b64_tr_b16 a[144:145], v4 offset:4096
    ds_read_b64_tr_b16 a[146:147], v4 offset:5120
    buffer_load_dwordx4 v3, s[32:35], s75 offen offset:1024 lds
    ds_read_b64_tr_b16 a[148:149], v5 offset:4096
    ds_read_b64_tr_b16 a[150:151], v5 offset:5120
    s_waitcnt lgkmcnt(12)
    s_add_u32 m0, s72, 22528
    s_cmp_gt_u32 s4, 27
    s_cselect_b32 s75, s1, s3
    s_add_u32 s75, s75, 1769472
    buffer_load_dwordx4 v2, s[32:35], s75 offen lds
    s_waitcnt vmcnt(15)
    ds_read_b64_tr_b16 a[152:153], v4 offset:6144
    ds_read_b64_tr_b16 a[154:155], v4 offset:7168
    buffer_load_dwordx4 v3, s[32:35], s75 offen offset:1024 lds
    ds_read_b64_tr_b16 a[156:157], v5 offset:6144
    ds_read_b64_tr_b16 a[158:159], v5 offset:7168
    v_mul_u32_u24 v2, 896, v8
    v_add_u32 v2, v2, v9
    v_add_u32 v3, 6144, v2
    s_mul_i32 s1, s48, 100352
    s_lshl_b32 s69, s58, 7
    s_add_u32 s1, s1, s69
    s_waitcnt lgkmcnt(12)
    s_add_u32 m0, s72, 0
    s_add_u32 s75, s1, 0
    buffer_load_dwordx4 v2, s[20:23], s75 offen lds
    s_waitcnt vmcnt(15)
    ds_read_b64_tr_b16 a[160:161], v4 offset:8192
    ds_read_b64_tr_b16 a[162:163], v4 offset:9216
    buffer_load_dwordx4 v3, s[20:23], s75 offen offset:1024 lds
    ds_read_b64_tr_b16 a[164:165], v5 offset:8192
    ds_read_b64_tr_b16 a[166:167], v5 offset:9216
    s_waitcnt lgkmcnt(12)
    s_add_u32 m0, s72, 2048
    s_add_u32 s75, s1, 14336
    buffer_load_dwordx4 v2, s[20:23], s75 offen lds
    s_waitcnt vmcnt(15)
    ds_read_b64_tr_b16 a[168:169], v4 offset:10240
    ds_read_b64_tr_b16 a[170:171], v4 offset:11264
    buffer_load_dwordx4 v3, s[20:23], s75 offen offset:1024 lds
    ds_read_b64_tr_b16 a[172:173], v5 offset:10240
    ds_read_b64_tr_b16 a[174:175], v5 offset:11264
    s_waitcnt lgkmcnt(12)
    s_add_u32 m0, s72, 4096
    s_add_u32 s75, s1, 25088
    buffer_load_dwordx4 v2, s[20:23], s75 offen lds
    s_waitcnt vmcnt(15)
    ds_read_b64_tr_b16 a[176:177], v4 offset:12288
    ds_read_b64_tr_b16 a[178:179], v4 offset:13312
    buffer_load_dwordx4 v3, s[20:23], s75 offen offset:1024 lds
    ds_read_b64_tr_b16 a[180:181], v5 offset:12288
    ds_read_b64_tr_b16 a[182:183], v5 offset:13312
    buffer_load_dword v250, v243, s[44:47], s67 offen sc1
    buffer_load_dword v251, v245, s[44:47], s62 offen sc1
    s_waitcnt lgkmcnt(12)
    s_add_u32 m0, s72, 6144
    s_add_u32 s75, s1, 39424
    buffer_load_dwordx4 v2, s[20:23], s75 offen lds
    s_waitcnt vmcnt(17)
    ds_read_b64_tr_b16 a[184:185], v4 offset:14336
    ds_read_b64_tr_b16 a[186:187], v4 offset:15360
    buffer_load_dwordx4 v3, s[20:23], s75 offen offset:1024 lds
    ds_read_b64_tr_b16 a[188:189], v5 offset:14336
    ds_read_b64_tr_b16 a[190:191], v5 offset:15360
    s_waitcnt lgkmcnt(12)
    s_add_u32 m0, s72, 8192
    s_add_u32 s75, s1, 50176
    buffer_load_dwordx4 v2, s[20:23], s75 offen lds
    s_waitcnt vmcnt(17)
    ds_read_b64_tr_b16 a[192:193], v4 offset:16384
    ds_read_b64_tr_b16 a[194:195], v4 offset:17408
    buffer_load_dwordx4 v3, s[20:23], s75 offen offset:1024 lds
    ds_read_b64_tr_b16 a[196:197], v5 offset:16384
    ds_read_b64_tr_b16 a[198:199], v5 offset:17408
    s_waitcnt lgkmcnt(12)
    s_add_u32 m0, s72, 10240
    s_add_u32 s75, s1, 64512
    buffer_load_dwordx4 v2, s[20:23], s75 offen lds
    s_waitcnt vmcnt(17)
    ds_read_b64_tr_b16 a[200:201], v4 offset:18432
    ds_read_b64_tr_b16 a[202:203], v4 offset:19456
    buffer_load_dwordx4 v3, s[20:23], s75 offen offset:1024 lds
    ds_read_b64_tr_b16 a[204:205], v5 offset:18432
    ds_read_b64_tr_b16 a[206:207], v5 offset:19456
    s_waitcnt lgkmcnt(12)
    s_add_u32 m0, s72, 12288
    s_add_u32 s75, s1, 75264
    buffer_load_dwordx4 v2, s[20:23], s75 offen lds
    s_waitcnt vmcnt(17)
    ds_read_b64_tr_b16 a[208:209], v4 offset:20480
    ds_read_b64_tr_b16 a[210:211], v4 offset:21504
    buffer_load_dwordx4 v3, s[20:23], s75 offen offset:1024 lds
    ds_read_b64_tr_b16 a[212:213], v5 offset:20480
    ds_read_b64_tr_b16 a[214:215], v5 offset:21504
    s_waitcnt lgkmcnt(12)
    s_add_u32 m0, s72, 14336
    s_add_u32 s75, s1, 89600
    buffer_load_dwordx4 v2, s[20:23], s75 offen lds
    s_waitcnt vmcnt(17)
    ds_read_b64_tr_b16 a[216:217], v4 offset:22528
    ds_read_b64_tr_b16 a[218:219], v4 offset:23552
    buffer_load_dwordx4 v3, s[20:23], s75 offen offset:1024 lds
    ds_read_b64_tr_b16 a[220:221], v5 offset:22528
    ds_read_b64_tr_b16 a[222:223], v5 offset:23552
L_join:
    s_waitcnt vmcnt(10)
    s_mov_b32 s74, 200000
L_poll_13:
    v_cmp_ne_u32 vcc, s51, v251
    s_nop 1
    s_cmp_eq_u64 vcc, 0
    s_cbranch_scc1 L_pdone_14
    s_sleep 1
    buffer_load_dword v251, v245, s[44:47], s62 offen sc1
    s_waitcnt vmcnt(0)
    s_sub_u32 s74, s74, 1
    s_cmp_lg_u32 s74, 0
    s_cbranch_scc1 L_poll_13
L_pdone_14:
    s_cmp_gt_u32 s73, 0
    s_cselect_b32 s7, s5, s6
    buffer_load_dwordx4 v[96:99], v6, s[44:47], s7 offen sc1
    buffer_load_dwordx4 v[100:103], v7, s[44:47], s7 offen sc1
    v_lshl_add_u32 v4, v240, 9, v10
    s_lshr_b32 s69, s48, 1
    s_and_b32 s69, s69, 1
    s_lshl_b32 s69, s69, 6
    v_xor_b32 v4, s69, v4
    v_xor_b32 v5, 64, v4
    ds_read_b64_tr_b16 a[224:225], v4 offset:0
    ds_read_b64_tr_b16 a[226:227], v4 offset:1024
    ds_read_b64_tr_b16 a[228:229], v5 offset:0
    ds_read_b64_tr_b16 a[230:231], v5 offset:1024
    s_cmp_gt_u32 s73, 1
    s_cselect_b32 s7, s5, s6
    s_add_u32 s7, s7, 2048
    buffer_load_dwordx4 v[104:107], v6, s[44:47], s7 offen sc1
    buffer_load_dwordx4 v[108:111], v7, s[44:47], s7 offen sc1
    s_mov_b32 s74, 200000
L_poll_15:
    v_cmp_ne_u32 vcc, s51, v250
    s_nop 1
    s_cmp_eq_u64 vcc, 0
    s_cbranch_scc1 L_pdone_16
    s_sleep 1
    buffer_load_dword v250, v243, s[44:47], s67 offen sc1
    s_waitcnt vmcnt(0)
    s_sub_u32 s74, s74, 1
    s_cmp_lg_u32 s74, 0
    s_cbranch_scc1 L_poll_15
L_pdone_16:
    buffer_load_dwordx4 v[160:163], v1, s[44:47], s61 offen offset:0 sc1
    buffer_load_dwordx4 v[164:167], v1, s[44:47], s61 offen offset:1024 sc1
    buffer_load_dwordx4 v[168:171], v1, s[44:47], s61 offen offset:2048 sc1
    buffer_load_dwordx4 v[172:175], v1, s[44:47], s61 offen offset:3072 sc1
    ds_read_b64_tr_b16 a[232:233], v4 offset:2048
    ds_read_b64_tr_b16 a[234:235], v4 offset:3072
    ds_read_b64_tr_b16 a[236:237], v5 offset:2048
    ds_read_b64_tr_b16 a[238:239], v5 offset:3072
    s_cmp_gt_u32 s73, 2
    s_cselect_b32 s7, s5, s6
    s_add_u32 s7, s7, 4096
    buffer_load_dwordx4 v[112:115], v6, s[44:47], s7 offen sc1
    buffer_load_dwordx4 v[116:119], v7, s[44:47], s7 offen sc1
    ds_read_b64_tr_b16 a[240:241], v4 offset:4096
    ds_read_b64_tr_b16 a[242:243], v4 offset:5120
    ds_read_b64_tr_b16 a[244:245], v5 offset:4096
    ds_read_b64_tr_b16 a[246:247], v5 offset:5120
    s_cmp_gt_u32 s73, 3
    s_cselect_b32 s7, s5, s6
    s_add_u32 s7, s7, 6144
    buffer_load_dwordx4 v[120:123], v6, s[44:47], s7 offen sc1
    buffer_load_dwordx4 v[124:127], v7, s[44:47], s7 offen sc1
    s_waitcnt vmcnt(20)
    ds_read_b64_tr_b16 a[248:249], v4 offset:6144
    ds_read_b64_tr_b16 a[250:251], v4 offset:7168
    ds_read_b64_tr_b16 a[252:253], v5 offset:6144
    ds_read_b64_tr_b16 a[254:255], v5 offset:7168
    s_cmp_gt_u32 s73, 4
    s_cselect_b32 s7, s5, s6
    s_add_u32 s7, s7, 8192
    buffer_load_dwordx4 v[128:131], v6, s[44:47], s7 offen sc1
    buffer_load_dwordx4 v[132:135], v7, s[44:47], s7 offen sc1
    s_cmp_gt_u32 s73, 5
    s_cselect_b32 s7, s5, s6
    s_add_u32 s7, s7, 10240
    buffer_load_dwordx4 v[136:139], v6, s[44:47], s7 offen sc1
    buffer_load_dwordx4 v[140:143], v7, s[44:47], s7 offen sc1
    s_cmp_gt_u32 s73, 6
    s_cselect_b32 s7, s5, s6
    s_add_u32 s7, s7, 12288
    buffer_load_dwordx4 v[144:147], v6, s[44:47], s7 offen sc1
    buffer_load_dwordx4 v[148:151], v7, s[44:47], s7 offen sc1
    s_waitcnt vmcnt(10)
    v_mfma_f32_32x32x16_bf16 v[176:191], v[160:163], v[208:211], 0
    v_mfma_f32_32x32x16_bf16 v[192:207], v[168:171], v[216:219], 0
    v_mfma_f32_32x32x16_bf16 v[176:191], v[164:167], v[212:215], v[176:191]
    v_mfma_f32_32x32x16_bf16 v[192:207], v[172:175], v[220:223], v[192:207]
    s_nop 10
    v_rcp_f32 v80, v189
    v_rcp_f32 v81, v205
    v_mov_b32 v84, 0x358637bd
    v_fma_f32 v84, v188, v80, v84
    v_fma_f32 v84, v204, v81, v84
    v_rcp_f32 v84, v84
    v_cndmask_b32 v188, v188, 0, s[70:71]
    v_cndmask_b32 v204, v204, 0, s[70:71]
    v_cndmask_b32 v189, v189, 0, s[70:71]
    v_cndmask_b32 v205, v205, 0, s[70:71]
    v_mul_f32 v80, v80, v84
    v_mul_f32 v81, v81, v84
    v_mov_b32 v82, v80
    v_mov_b32 v86, v81
    s_nop 0
    v_permlane32_swap_b32 v80, v82
    v_permlane32_swap_b32 v81, v86
.p2align 3
    v_pk_mul_f32 v[176:177], v[176:177], v[82:83] op_sel_hi:[1,0]
    v_pk_mul_f32 v[178:179], v[178:179], v[82:83] op_sel_hi:[1,0]
    v_pk_mul_f32 v[180:181], v[180:181], v[82:83] op_sel_hi:[1,0]
    v_pk_mul_f32 v[182:183], v[182:183], v[82:83] op_sel_hi:[1,0]
    v_pk_mul_f32 v[184:185], v[184:185], v[82:83] op_sel_hi:[1,0]
    v_pk_mul_f32 v[186:187], v[186:187], v[82:83] op_sel_hi:[1,0]
    v_pk_mul_f32 v[188:189], v[188:189], v[82:83] op_sel_hi:[1,0]
    v_pk_mul_f32 v[190:191], v[190:191], v[82:83] op_sel_hi:[1,0]
.p2align 3
    v_pk_fma_f32 v[176:177], v[192:193], v[86:87], v[176:177] op_sel_hi:[1,0,1]
    v_pk_fma_f32 v[178:179], v[194:195], v[86:87], v[178:179] op_sel_hi:[1,0,1]
    v_pk_fma_f32 v[180:181], v[196:197], v[86:87], v[180:181] op_sel_hi:[1,0,1]
    v_pk_fma_f32 v[182:183], v[198:199], v[86:87], v[182:183] op_sel_hi:[1,0,1]
    v_pk_fma_f32 v[184:185], v[200:201], v[86:87], v[184:185] op_sel_hi:[1,0,1]
    v_pk_fma_f32 v[186:187], v[202:203], v[86:87], v[186:187] op_sel_hi:[1,0,1]
    v_pk_fma_f32 v[188:189], v[204:205], v[86:87], v[188:189] op_sel_hi:[1,0,1]
    v_pk_fma_f32 v[190:191], v[206:207], v[86:87], v[190:191] op_sel_hi:[1,0,1]
.p2align 3
    v_cvt_pk_bf16_f32 v88, v176, v177
    v_cvt_pk_bf16_f32 v89, v178, v179
    v_cvt_pk_bf16_f32 v90, v180, v181
    v_cvt_pk_bf16_f32 v91, v182, v183
    v_cvt_pk_bf16_f32 v92, v184, v185
    v_cvt_pk_bf16_f32 v93, v186, v187
    v_cvt_pk_bf16_f32 v94, v188, v189
    v_cvt_pk_bf16_f32 v95, v190, v191
    buffer_store_dwordx4 v[88:91], v1, s[44:47], s65 offen offset:0 sc1
    buffer_store_dwordx4 v[92:95], v1, s[44:47], s65 offen offset:2048 sc1
L_f2:
    v_permlane32_swap_b32 v224, v226
    v_permlane32_swap_b32 v225, v227
    v_permlane32_swap_b32 v228, v230
    v_permlane32_swap_b32 v229, v231
    v_lshlrev_b32 v16, 16, v224
    v_and_b32 v17, s0, v224
    v_lshlrev_b32 v18, 16, v225
    v_and_b32 v19, s0, v225
    v_lshlrev_b32 v20, 16, v226
    v_and_b32 v21, s0, v226
    v_lshlrev_b32 v22, 16, v227
    v_and_b32 v23, s0, v227
    v_lshlrev_b32 v24, 16, v228
    v_and_b32 v25, s0, v228
    v_lshlrev_b32 v26, 16, v229
    v_and_b32 v27, s0, v229
    v_lshlrev_b32 v28, 16, v230
    v_and_b32 v29, s0, v230
    v_lshlrev_b32 v30, 16, v231
    v_and_b32 v31, s0, v231
    v_lshlrev_b32 v232, 16, v232
.p2align 3
    v_pk_add_f32 v[16:17], v[16:17], v[232:233] op_sel_hi:[1,0]
    v_pk_add_f32 v[18:19], v[18:19], v[232:233] op_sel_hi:[1,0]
    v_pk_add_f32 v[20:21], v[20:21], v[232:233] op_sel_hi:[1,0]
    v_pk_add_f32 v[22:23], v[22:23], v[232:233] op_sel_hi:[1,0]
    v_pk_add_f32 v[24:25], v[24:25], v[232:233] op_sel_hi:[1,0]
    v_pk_add_f32 v[26:27], v[26:27], v[232:233] op_sel_hi:[1,0]
    v_pk_add_f32 v[28:29], v[28:29], v[232:233] op_sel_hi:[1,0]
    v_pk_add_f32 v[30:31], v[30:31], v[232:233] op_sel_hi:[1,0]
    s_nop 1
    v_mfma_f32_32x32x16_bf16 v[16:31], v[96:99], a[0:3], v[16:31]
    s_cmp_gt_u32 s73, 7
    s_cselect_b32 s7, s5, s6
    v_mfma_f32_32x32x16_bf16 v[32:47], v[96:99], a[4:7], 0
    s_add_u32 s7, s7, 14336
    v_mfma_f32_32x32x16_bf16 v[48:63], v[100:103], a[0:3], 0
    buffer_load_dwordx4 v[152:155], v6, s[44:47], s7 offen sc1
    v_mfma_f32_32x32x16_bf16 v[64:79], v[100:103], a[4:7], 0
    buffer_load_dwordx4 v[156:159], v7, s[44:47], s7 offen sc1
    v_mfma_f32_32x32x16_bf16 v[16:31], v[104:107], a[8:11], v[16:31]
    s_cmp_gt_u32 s73, 8
    s_cselect_b32 s7, s5, s6
    s_add_u32 s7, s7, 16384
    v_mfma_f32_32x32x16_bf16 v[32:47], v[104:107], a[12:15], v[32:47]
    buffer_load_dwordx4 v[96:99], v6, s[44:47], s7 offen sc1
    ds_read_b64_tr_b16 a[0:1], v4 offset:8192
    v_mfma_f32_32x32x16_bf16 v[48:63], v[108:111], a[8:11], v[48:63]
    ds_read_b64_tr_b16 a[2:3], v4 offset:9216
    buffer_load_dwordx4 v[100:103], v7, s[44:47], s7 offen sc1
    v_mfma_f32_32x32x16_bf16 v[64:79], v[108:111], a[12:15], v[64:79]
    ds_read_b64_tr_b16 a[4:5], v5 offset:8192
    ds_read_b64_tr_b16 a[6:7], v5 offset:9216
    s_waitcnt vmcnt(14)
    v_mfma_f32_32x32x16_bf16 v[16:31], v[112:115], a[16:19], v[16:31]
    s_cmp_gt_u32 s73, 9
    s_cselect_b32 s7, s5, s6
    s_add_u32 s7, s7, 18432
    v_mfma_f32_32x32x16_bf16 v[32:47], v[112:115], a[20:23], v[32:47]
    buffer_load_dwordx4 v[104:107], v6, s[44:47], s7 offen sc1
    ds_read_b64_tr_b16 a[8:9], v4 offset:10240
    v_mfma_f32_32x32x16_bf16 v[48:63], v[116:119], a[16:19], v[48:63]
    ds_read_b64_tr_b16 a[10:11], v4 offset:11264
    buffer_load_dwordx4 v[108:111], v7, s[44:47], s7 offen sc1
    v_mfma_f32_32x32x16_bf16 v[64:79], v[116:119], a[20:23], v[64:79]
    ds_read_b64_tr_b16 a[12:13], v5 offset:10240
    ds_read_b64_tr_b16 a[14:15], v5 offset:11264
    s_waitcnt vmcnt(14)
    v_mfma_f32_32x32x16_bf16 v[16:31], v[120:123], a[24:27], v[16:31]
    s_cmp_gt_u32 s73, 10
    s_cselect_b32 s7, s5, s6
    s_add_u32 s7, s7, 20480
    v_mfma_f32_32x32x16_bf16 v[32:47], v[120:123], a[28:31], v[32:47]
    buffer_load_dwordx4 v[112:115], v6, s[44:47], s7 offen sc1
    ds_read_b64_tr_b16 a[16:17], v4 offset:12288
    v_mfma_f32_32x32x16_bf16 v[48:63], v[124:127], a[24:27], v[48:63]
    ds_read_b64_tr_b16 a[18:19], v4 offset:13312
    buffer_load_dwordx4 v[116:119], v7, s[44:47], s7 offen sc1
    v_mfma_f32_32x32x16_bf16 v[64:79], v[124:127], a[28:31], v[64:79]
    ds_read_b64_tr_b16 a[20:21], v5 offset:12288
    ds_read_b64_tr_b16 a[22:23], v5 offset:13312
    s_waitcnt vmcnt(14)
    v_mfma_f32_32x32x16_bf16 v[16:31], v[128:131], a[32:35], v[16:31]
    s_cmp_gt_u32 s73, 11
    s_cselect_b32 s7, s5, s6
    s_add_u32 s7, s7, 22528
    v_mfma_f32_32x32x16_bf16 v[32:47], v[128:131], a[36:39], v[32:47]
    buffer_load_dwordx4 v[120:123], v6, s[44:47], s7 offen sc1
    ds_read_b64_tr_b16 a[24:25], v4 offset:14336
    v_mfma_f32_32x32x16_bf16 v[48:63], v[132:135], a[32:35], v[48:63]
    ds_read_b64_tr_b16 a[26:27], v4 offset:15360
    buffer_load_dwordx4 v[124:127], v7, s[44:47], s7 offen sc1
    v_mfma_f32_32x32x16_bf16 v[64:79], v[132:135], a[36:39], v[64:79]
    ds_read_b64_tr_b16 a[28:29], v5 offset:14336
    ds_read_b64_tr_b16 a[30:31], v5 offset:15360
    s_waitcnt vmcnt(14)
    v_mfma_f32_32x32x16_bf16 v[16:31], v[136:139], a[40:43], v[16:31]
    s_cmp_gt_u32 s73, 12
    s_cselect_b32 s7, s5, s6
    v_mfma_f32_32x32x16_bf16 v[32:47], v[136:139], a[44:47], v[32:47]
    s_add_u32 s7, s7, 24576
    v_mfma_f32_32x32x16_bf16 v[48:63], v[140:143], a[40:43], v[48:63]
    buffer_load_dwordx4 v[128:131], v6, s[44:47], s7 offen sc1
    v_mfma_f32_32x32x16_bf16 v[64:79], v[140:143], a[44:47], v[64:79]
    buffer_load_dwordx4 v[132:135], v7, s[44:47], s7 offen sc1
    s_waitcnt vmcnt(14)
    v_mfma_f32_32x32x16_bf16 v[16:31], v[144:147], a[48:51], v[16:31]
    s_waitcnt vmcnt(12)
    s_barrier
    s_cmp_lg_u32 s48, 0
    s_cbranch_scc1 L_wf_17
    v_mov_b32 v249, s51
    v_mov_b32 v248, 0
    s_mov_b64 exec, 1
    buffer_store_dword v249, v248, s[44:47], s64 offen sc1
    s_mov_b64 exec, -1
L_wf_17:
    v_mfma_f32_32x32x16_bf16 v[32:47], v[144:147], a[52:55], v[32:47]
    s_cmp_gt_u32 s73, 13
    s_cselect_b32 s7, s5, s6
    v_mfma_f32_32x32x16_bf16 v[48:63], v[148:151], a[48:51], v[48:63]
    s_add_u32 s7, s7, 26624
    buffer_load_dwordx4 v[136:139], v6, s[44:47], s7 offen sc1
    v_mfma_f32_32x32x16_bf16 v[64:79], v[148:151], a[52:55], v[64:79]
    buffer_load_dwordx4 v[140:143], v7, s[44:47], s7 offen sc1
    s_waitcnt vmcnt(12)
    v_mfma_f32_32x32x16_bf16 v[16:31], v[152:155], a[56:59], v[16:31]
    s_cmp_gt_u32 s73, 14
    s_cselect_b32 s7, s5, s6
    v_mfma_f32_32x32x16_bf16 v[32:47], v[152:155], a[60:63], v[32:47]
    s_add_u32 s7, s7, 28672
    v_mfma_f32_32x32x16_bf16 v[48:63], v[156:159], a[56:59], v[48:63]
    buffer_load_dwordx4 v[144:147], v6, s[44:47], s7 offen sc1
    v_mfma_f32_32x32x16_bf16 v[64:79], v[156:159], a[60:63], v[64:79]
    buffer_load_dwordx4 v[148:151], v7, s[44:47], s7 offen sc1
    s_waitcnt vmcnt(12)
    v_mfma_f32_32x32x16_bf16 v[16:31], v[96:99], a[64:67], v[16:31]
    s_cmp_gt_u32 s73, 15
    s_cselect_b32 s7, s5, s6
    v_mfma_f32_32x32x16_bf16 v[32:47], v[96:99], a[68:71], v[32:47]
    s_add_u32 s7, s7, 30720
    v_mfma_f32_32x32x16_bf16 v[48:63], v[100:103], a[64:67], v[48:63]
    buffer_load_dwordx4 v[152:155], v6, s[44:47], s7 offen sc1
    v_mfma_f32_32x32x16_bf16 v[64:79], v[100:103], a[68:71], v[64:79]
    buffer_load_dwordx4 v[156:159], v7, s[44:47], s7 offen sc1
    s_waitcnt vmcnt(12)
    v_mfma_f32_32x32x16_bf16 v[16:31], v[104:107], a[72:75], v[16:31]
    s_cmp_gt_u32 s73, 16
    s_cselect_b32 s7, s5, s6
    v_mfma_f32_32x32x16_bf16 v[32:47], v[104:107], a[76:79], v[32:47]
    s_add_u32 s7, s7, 32768
    v_mfma_f32_32x32x16_bf16 v[48:63], v[108:111], a[72:75], v[48:63]
    buffer_load_dwordx4 v[96:99], v6, s[44:47], s7 offen sc1
    v_mfma_f32_32x32x16_bf16 v[64:79], v[108:111], a[76:79], v[64:79]
    buffer_load_dwordx4 v[100:103], v7, s[44:47], s7 offen sc1
    s_waitcnt vmcnt(12)
    v_mfma_f32_32x32x16_bf16 v[16:31], v[112:115], a[80:83], v[16:31]
    s_cmp_gt_u32 s73, 17
    s_cselect_b32 s7, s5, s6
    v_mfma_f32_32x32x16_bf16 v[32:47], v[112:115], a[84:87], v[32:47]
    s_add_u32 s7, s7, 34816
    v_mfma_f32_32x32x16_bf16 v[48:63], v[116:119], a[80:83], v[48:63]
    buffer_load_dwordx4 v[104:107], v6, s[44:47], s7 offen sc1
    v_mfma_f32_32x32x16_bf16 v[64:79], v[116:119], a[84:87], v[64:79]
    buffer_load_dwordx4 v[108:111], v7, s[44:47], s7 offen sc1
    s_waitcnt vmcnt(12)
    v_mfma_f32_32x32x16_bf16 v[16:31], v[120:123], a[88:91], v[16:31]
    s_cmp_gt_u32 s73, 18
    s_cselect_b32 s7, s5, s6
    v_mfma_f32_32x32x16_bf16 v[32:47], v[120:123], a[92:95], v[32:47]
    s_add_u32 s7, s7, 36864
    v_mfma_f32_32x32x16_bf16 v[48:63], v[124:127], a[88:91], v[48:63]
    buffer_load_dwordx4 v[112:115], v6, s[44:47], s7 offen sc1
    v_mfma_f32_32x32x16_bf16 v[64:79], v[124:127], a[92:95], v[64:79]
    buffer_load_dwordx4 v[116:119], v7, s[44:47], s7 offen sc1
    s_waitcnt vmcnt(12)
    v_mfma_f32_32x32x16_bf16 v[16:31], v[128:131], a[96:99], v[16:31]
    s_cmp_gt_u32 s73, 19
    s_cselect_b32 s7, s5, s6
    v_mfma_f32_32x32x16_bf16 v[32:47], v[128:131], a[100:103], v[32:47]
    s_add_u32 s7, s7, 38912
    v_mfma_f32_32x32x16_bf16 v[48:63], v[132:135], a[96:99], v[48:63]
    buffer_load_dwordx4 v[120:123], v6, s[44:47], s7 offen sc1
    v_mfma_f32_32x32x16_bf16 v[64:79], v[132:135], a[100:103], v[64:79]
    buffer_load_dwordx4 v[124:127], v7, s[44:47], s7 offen sc1
    s_waitcnt vmcnt(12)
    v_mfma_f32_32x32x16_bf16 v[16:31], v[136:139], a[104:107], v[16:31]
    buffer_load_dword v250, v246, s[44:47], s66 offen sc1
    v_mfma_f32_32x32x16_bf16 v[32:47], v[136:139], a[108:111], v[32:47]
    s_cmp_gt_u32 s73, 20
    s_cselect_b32 s7, s5, s6
    s_add_u32 s7, s7, 40960
    v_mfma_f32_32x32x16_bf16 v[48:63], v[140:143], a[104:107], v[48:63]
    buffer_load_dwordx4 v[128:131], v6, s[44:47], s7 offen sc1
    v_mfma_f32_32x32x16_bf16 v[64:79], v[140:143], a[108:111], v[64:79]
    buffer_load_dwordx4 v[132:135], v7, s[44:47], s7 offen sc1
    s_waitcnt vmcnt(13)
    v_mfma_f32_32x32x16_bf16 v[16:31], v[144:147], a[112:115], v[16:31]
    s_cmp_gt_u32 s73, 21
    s_cselect_b32 s7, s5, s6
    v_mfma_f32_32x32x16_bf16 v[32:47], v[144:147], a[116:119], v[32:47]
    s_add_u32 s7, s7, 43008
    v_mfma_f32_32x32x16_bf16 v[48:63], v[148:151], a[112:115], v[48:63]
    buffer_load_dwordx4 v[136:139], v6, s[44:47], s7 offen sc1
    v_mfma_f32_32x32x16_bf16 v[64:79], v[148:151], a[116:119], v[64:79]
    buffer_load_dwordx4 v[140:143], v7, s[44:47], s7 offen sc1
    s_waitcnt vmcnt(13)
    v_mfma_f32_32x32x16_bf16 v[16:31], v[152:155], a[120:123], v[16:31]
    s_cmp_gt_u32 s73, 22
    s_cselect_b32 s7, s5, s6
    v_mfma_f32_32x32x16_bf16 v[32:47], v[152:155], a[124:127], v[32:47]
    s_add_u32 s7, s7, 45056
    v_mfma_f32_32x32x16_bf16 v[48:63], v[156:159], a[120:123], v[48:63]
    buffer_load_dwordx4 v[144:147], v6, s[44:47], s7 offen sc1
    v_mfma_f32_32x32x16_bf16 v[64:79], v[156:159], a[124:127], v[64:79]
    buffer_load_dwordx4 v[148:151], v7, s[44:47], s7 offen sc1
    s_waitcnt vmcnt(13)
    v_mfma_f32_32x32x16_bf16 v[16:31], v[96:99], a[128:131], v[16:31]
    s_cmp_gt_u32 s73, 23
    s_cselect_b32 s7, s5, s6
    v_mfma_f32_32x32x16_bf16 v[32:47], v[96:99], a[132:135], v[32:47]
    s_add_u32 s7, s7, 47104
    v_mfma_f32_32x32x16_bf16 v[48:63], v[100:103], a[128:131], v[48:63]
    buffer_load_dwordx4 v[152:155], v6, s[44:47], s7 offen sc1
    v_mfma_f32_32x32x16_bf16 v[64:79], v[100:103], a[132:135], v[64:79]
    buffer_load_dwordx4 v[156:159], v7, s[44:47], s7 offen sc1
    s_waitcnt vmcnt(13)
    v_mfma_f32_32x32x16_bf16 v[16:31], v[104:107], a[136:139], v[16:31]
    s_cmp_gt_u32 s73, 24
    s_cselect_b32 s7, s5, s6
    v_mfma_f32_32x32x16_bf16 v[32:47], v[104:107], a[140:143], v[32:47]
    s_add_u32 s7, s7, 49152
    v_mfma_f32_32x32x16_bf16 v[48:63], v[108:111], a[136:139], v[48:63]
    buffer_load_dwordx4 v[96:99], v6, s[44:47], s7 offen sc1
    v_mfma_f32_32x32x16_bf16 v[64:79], v[108:111], a[140:143], v[64:79]
    buffer_load_dwordx4 v[100:103], v7, s[44:47], s7 offen sc1
    s_waitcnt vmcnt(13)
    v_mfma_f32_32x32x16_bf16 v[16:31], v[112:115], a[144:147], v[16:31]
    s_cmp_gt_u32 s73, 25
    s_cselect_b32 s7, s5, s6
    v_mfma_f32_32x32x16_bf16 v[32:47], v[112:115], a[148:151], v[32:47]
    s_add_u32 s7, s7, 51200
    v_mfma_f32_32x32x16_bf16 v[48:63], v[116:119], a[144:147], v[48:63]
    buffer_load_dwordx4 v[104:107], v6, s[44:47], s7 offen sc1
    v_mfma_f32_32x32x16_bf16 v[64:79], v[116:119], a[148:151], v[64:79]
    buffer_load_dwordx4 v[108:111], v7, s[44:47], s7 offen sc1
    s_waitcnt vmcnt(13)
    v_mfma_f32_32x32x16_bf16 v[16:31], v[120:123], a[152:155], v[16:31]
    s_cmp_gt_u32 s73, 26
    s_cselect_b32 s7, s5, s6
    v_mfma_f32_32x32x16_bf16 v[32:47], v[120:123], a[156:159], v[32:47]
    s_add_u32 s7, s7, 53248
    v_mfma_f32_32x32x16_bf16 v[48:63], v[124:127], a[152:155], v[48:63]
    buffer_load_dwordx4 v[112:115], v6, s[44:47], s7 offen sc1
    v_mfma_f32_32x32x16_bf16 v[64:79], v[124:127], a[156:159], v[64:79]
    buffer_load_dwordx4 v[116:119], v7, s[44:47], s7 offen sc1
    s_waitcnt vmcnt(12)
    v_mfma_f32_32x32x16_bf16 v[16:31], v[128:131], a[160:163], v[16:31]
    s_cmp_gt_u32 s73, 27
    s_cselect_b32 s7, s5, s6
    v_mfma_f32_32x32x16_bf16 v[32:47], v[128:131], a[164:167], v[32:47]
    s_add_u32 s7, s7, 55296
    v_mfma_f32_32x32x16_bf16 v[48:63], v[132:135], a[160:163], v[48:63]
    buffer_load_dwordx4 v[120:123], v6, s[44:47], s7 offen sc1
    v_mfma_f32_32x32x16_bf16 v[64:79], v[132:135], a[164:167], v[64:79]
    buffer_load_dwordx4 v[124:127], v7, s[44:47], s7 offen sc1
    s_waitcnt vmcnt(12)
    v_mfma_f32_32x32x16_bf16 v[16:31], v[136:139], a[168:171], v[16:31]
    s_mov_b32 s74, 200000
L_poll_18:
    v_cmp_ne_u32 vcc, s51, v250
    s_nop 1
    s_cmp_eq_u64 vcc, 0
    s_cbranch_scc1 L_pdone_19
    s_sleep 1
    buffer_load_dword v250, v246, s[44:47], s66 offen sc1
    s_waitcnt vmcnt(0)
    s_sub_u32 s74, s74, 1
    s_cmp_lg_u32 s74, 0
    s_cbranch_scc1 L_poll_18
L_pdone_19:
    v_mfma_f32_32x32x16_bf16 v[32:47], v[136:139], a[172:175], v[32:47]
    s_lshr_b32 s69, s48, 0
    s_and_b32 s69, s69, 1
    s_lshl_b32 s69, s69, 10
    v_mfma_f32_32x32x16_bf16 v[48:63], v[140:143], a[168:171], v[48:63]
    v_add_u32 v6, s69, v1
    v_xor_b32 v7, 0x400, v6
    s_add_u32 s7, s63, 0
    v_mfma_f32_32x32x16_bf16 v[64:79], v[140:143], a[172:175], v[64:79]
    buffer_load_dwordx4 v[128:131], v6, s[44:47], s7 offen sc1
    buffer_load_dwordx4 v[132:135], v7, s[44:47], s7 offen sc1
    s_waitcnt vmcnt(12)
    v_mfma_f32_32x32x16_bf16 v[16:31], v[144:147], a[176:179], v[16:31]
    s_add_u32 s7, s63, 2048
    v_mfma_f32_32x32x16_bf16 v[32:47], v[144:147], a[180:183], v[32:47]
    buffer_load_dwordx4 v[136:139], v6, s[44:47], s7 offen sc1
    v_mfma_f32_32x32x16_bf16 v[48:63], v[148:151], a[176:179], v[48:63]
    v_mfma_f32_32x32x16_bf16 v[64:79], v[148:151], a[180:183], v[64:79]
    buffer_load_dwordx4 v[140:143], v7, s[44:47], s7 offen sc1
    s_waitcnt vmcnt(12)
    v_mfma_f32_32x32x16_bf16 v[16:31], v[152:155], a[184:187], v[16:31]
    s_add_u32 s7, s63, 4096
    v_mfma_f32_32x32x16_bf16 v[32:47], v[152:155], a[188:191], v[32:47]
    buffer_load_dwordx4 v[144:147], v6, s[44:47], s7 offen sc1
    v_mfma_f32_32x32x16_bf16 v[48:63], v[156:159], a[184:187], v[48:63]
    v_mfma_f32_32x32x16_bf16 v[64:79], v[156:159], a[188:191], v[64:79]
    buffer_load_dwordx4 v[148:151], v7, s[44:47], s7 offen sc1
    s_waitcnt vmcnt(12)
    s_waitcnt lgkmcnt(15)
    v_mfma_f32_32x32x16_bf16 v[16:31], v[96:99], a[192:195], v[16:31]
    s_add_u32 s7, s63, 6144
    v_mfma_f32_32x32x16_bf16 v[32:47], v[96:99], a[196:199], v[32:47]
    buffer_load_dwordx4 v[152:155], v6, s[44:47], s7 offen sc1
    v_mfma_f32_32x32x16_bf16 v[48:63], v[100:103], a[192:195], v[48:63]
    v_mfma_f32_32x32x16_bf16 v[64:79], v[100:103], a[196:199], v[64:79]
    buffer_load_dwordx4 v[156:159], v7, s[44:47], s7 offen sc1
    s_waitcnt vmcnt(12)
    v_mfma_f32_32x32x16_bf16 v[16:31], v[104:107], a[200:203], v[16:31]
    s_add_u32 s7, s63, 8192
    v_mfma_f32_32x32x16_bf16 v[32:47], v[104:107], a[204:207], v[32:47]
    buffer_load_dwordx4 v[96:99], v6, s[44:47], s7 offen sc1
    v_mfma_f32_32x32x16_bf16 v[48:63], v[108:111], a[200:203], v[48:63]
    v_mfma_f32_32x32x16_bf16 v[64:79], v[108:111], a[204:207], v[64:79]
    buffer_load_dwordx4 v[100:103], v7, s[44:47], s7 offen sc1
    s_waitcnt vmcnt(12)
    v_mfma_f32_32x32x16_bf16 v[16:31], v[112:115], a[208:211], v[16:31]
    s_add_u32 s7, s63, 10240
    v_mfma_f32_32x32x16_bf16 v[32:47], v[112:115], a[212:215], v[32:47]
    buffer_load_dwordx4 v[104:107], v6, s[44:47], s7 offen sc1
    v_mfma_f32_32x32x16_bf16 v[48:63], v[116:119], a[208:211], v[48:63]
    v_mfma_f32_32x32x16_bf16 v[64:79], v[116:119], a[212:215], v[64:79]
    buffer_load_dwordx4 v[108:111], v7, s[44:47], s7 offen sc1
    s_waitcnt vmcnt(12)
    v_mfma_f32_32x32x16_bf16 v[16:31], v[120:123], a[216:219], v[16:31]
    s_add_u32 s7, s63, 12288
    v_mfma_f32_32x32x16_bf16 v[32:47], v[120:123], a[220:223], v[32:47]
    buffer_load_dwordx4 v[112:115], v6, s[44:47], s7 offen sc1
    v_mfma_f32_32x32x16_bf16 v[48:63], v[124:127], a[216:219], v[48:63]
    v_mfma_f32_32x32x16_bf16 v[64:79], v[124:127], a[220:223], v[64:79]
    buffer_load_dwordx4 v[116:119], v7, s[44:47], s7 offen sc1
    s_waitcnt vmcnt(12)
    v_mfma_f32_32x32x16_bf16 v[16:31], a[224:227], v[128:131], v[16:31]
    s_add_u32 s7, s63, 14336
    v_mfma_f32_32x32x16_bf16 v[32:47], a[224:227], v[132:135], v[32:47]
    buffer_load_dwordx4 v[120:123], v6, s[44:47], s7 offen sc1
    v_mfma_f32_32x32x16_bf16 v[48:63], a[228:231], v[128:131], v[48:63]
    v_mfma_f32_32x32x16_bf16 v[64:79], a[228:231], v[132:135], v[64:79]
    buffer_load_dwordx4 v[124:127], v7, s[44:47], s7 offen sc1
    s_waitcnt vmcnt(12)
    v_mfma_f32_32x32x16_bf16 v[16:31], a[232:235], v[136:139], v[16:31]
    v_mfma_f32_32x32x16_bf16 v[32:47], a[232:235], v[140:143], v[32:47]
    v_mfma_f32_32x32x16_bf16 v[48:63], a[236:239], v[136:139], v[48:63]
    v_mfma_f32_32x32x16_bf16 v[64:79], a[236:239], v[140:143], v[64:79]
    s_waitcnt vmcnt(10)
    v_mfma_f32_32x32x16_bf16 v[16:31], a[240:243], v[144:147], v[16:31]
    v_mfma_f32_32x32x16_bf16 v[32:47], a[240:243], v[148:151], v[32:47]
    v_mfma_f32_32x32x16_bf16 v[48:63], a[244:247], v[144:147], v[48:63]
    v_mfma_f32_32x32x16_bf16 v[64:79], a[244:247], v[148:151], v[64:79]
    s_waitcnt vmcnt(8)
    v_mfma_f32_32x32x16_bf16 v[16:31], a[248:251], v[152:155], v[16:31]
    v_mfma_f32_32x32x16_bf16 v[32:47], a[248:251], v[156:159], v[32:47]
    v_mfma_f32_32x32x16_bf16 v[48:63], a[252:255], v[152:155], v[48:63]
    v_mfma_f32_32x32x16_bf16 v[64:79], a[252:255], v[156:159], v[64:79]
    s_waitcnt vmcnt(6)
    s_waitcnt lgkmcnt(12)
    v_mfma_f32_32x32x16_bf16 v[64:79], a[4:7], v[100:103], v[64:79]
    s_xor_b32 s69, s48, 3
    s_mul_i32 s69, s69, 12288
    s_add_u32 s69, s69, 8192
    v_mfma_f32_32x32x16_bf16 v[48:63], a[4:7], v[96:99], v[48:63]
    v_add_u32 v14, s69, v1
    s_xor_b32 s69, s48, 2
    v_mfma_f32_32x32x16_bf16 v[32:47], a[0:3], v[100:103], v[32:47]
    s_mul_i32 s69, s69, 12288
    s_add_u32 s69, s69, 4096
    v_add_u32 v13, s69, v1
    s_waitcnt vmcnt(4)
    s_waitcnt lgkmcnt(8)
    v_mfma_f32_32x32x16_bf16 v[64:79], a[12:15], v[108:111], v[64:79]
    s_xor_b32 s69, s48, 1
    s_mul_i32 s69, s69, 12288
    v_mfma_f32_32x32x16_bf16 v[48:63], a[12:15], v[104:107], v[48:63]
    v_add_u32 v12, s69, v1
    s_xor_b32 s69, s48, 0
    v_mfma_f32_32x32x16_bf16 v[32:47], a[8:11], v[108:111], v[32:47]
    s_mul_i32 s69, s69, 12288
    v_add_u32 v11, s69, v1
    s_waitcnt vmcnt(2)
    s_waitcnt lgkmcnt(4)
    v_mfma_f32_32x32x16_bf16 v[64:79], a[20:23], v[116:119], v[64:79]
    v_mfma_f32_32x32x16_bf16 v[48:63], a[20:23], v[112:115], v[48:63]
    v_mfma_f32_32x32x16_bf16 v[32:47], a[16:19], v[116:119], v[32:47]
    s_waitcnt vmcnt(0)
    s_waitcnt lgkmcnt(0)
    v_mfma_f32_32x32x16_bf16 v[64:79], a[28:31], v[124:127], v[64:79]
    v_mfma_f32_32x32x16_bf16 v[48:63], a[28:31], v[120:123], v[48:63]
    v_mfma_f32_32x32x16_bf16 v[32:47], a[24:27], v[124:127], v[32:47]
    v_mfma_f32_32x32x16_bf16 v[16:31], a[0:3], v[96:99], v[16:31]
    s_nop 8
    ds_write_b128 v14, v[64:67] offset:0
    ds_write_b128 v14, v[68:71] offset:1024
    ds_write_b128 v14, v[72:75] offset:2048
    v_mfma_f32_32x32x16_bf16 v[16:31], a[8:11], v[104:107], v[16:31]
    ds_write_b128 v14, v[76:79] offset:3072
    ds_write_b128 v13, v[48:51] offset:0
    ds_write_b128 v13, v[52:55] offset:1024
    v_mfma_f32_32x32x16_bf16 v[16:31], a[16:19], v[112:115], v[16:31]
    ds_write_b128 v13, v[56:59] offset:2048
    ds_write_b128 v13, v[60:63] offset:3072
    ds_write_b128 v12, v[32:35] offset:0
    v_mfma_f32_32x32x16_bf16 v[16:31], a[24:27], v[120:123], v[16:31]
    ds_write_b128 v12, v[36:39] offset:1024
    ds_write_b128 v12, v[40:43] offset:2048
    ds_write_b128 v12, v[44:47] offset:3072
    s_waitcnt lgkmcnt(0)
    s_barrier
    ds_read_b128 v[96:99], v11 offset:0
    ds_read_b128 v[100:103], v11 offset:1024
    ds_read_b128 v[104:107], v11 offset:2048
    ds_read_b128 v[108:111], v11 offset:3072
    ds_read_b128 v[112:115], v11 offset:4096
    ds_read_b128 v[116:119], v11 offset:5120
    ds_read_b128 v[120:123], v11 offset:6144
    ds_read_b128 v[124:127], v11 offset:7168
    ds_read_b128 v[128:131], v11 offset:8192
    ds_read_b128 v[132:135], v11 offset:9216
    ds_read_b128 v[136:139], v11 offset:10240
    ds_read_b128 v[140:143], v11 offset:11264
    s_waitcnt lgkmcnt(8)
.p2align 3
    v_pk_add_f32 v[16:17], v[16:17], v[96:97]
    v_pk_add_f32 v[18:19], v[18:19], v[98:99]
    v_pk_add_f32 v[20:21], v[20:21], v[100:101]
    v_pk_add_f32 v[22:23], v[22:23], v[102:103]
    v_pk_add_f32 v[24:25], v[24:25], v[104:105]
    v_pk_add_f32 v[26:27], v[26:27], v[106:107]
    v_pk_add_f32 v[28:29], v[28:29], v[108:109]
    v_pk_add_f32 v[30:31], v[30:31], v[110:111]
    s_waitcnt lgkmcnt(4)
.p2align 3
    v_pk_add_f32 v[16:17], v[16:17], v[112:113]
    v_pk_add_f32 v[18:19], v[18:19], v[114:115]
    v_pk_add_f32 v[20:21], v[20:21], v[116:117]
    v_pk_add_f32 v[22:23], v[22:23], v[118:119]
    v_pk_add_f32 v[24:25], v[24:25], v[120:121]
    v_pk_add_f32 v[26:27], v[26:27], v[122:123]
    v_pk_add_f32 v[28:29], v[28:29], v[124:125]
    v_pk_add_f32 v[30:31], v[30:31], v[126:127]
    s_waitcnt lgkmcnt(0)
.p2align 3
    v_pk_add_f32 v[16:17], v[16:17], v[128:129]
    v_pk_add_f32 v[18:19], v[18:19], v[130:131]
    v_pk_add_f32 v[20:21], v[20:21], v[132:133]
    v_pk_add_f32 v[22:23], v[22:23], v[134:135]
    v_pk_add_f32 v[24:25], v[24:25], v[136:137]
    v_pk_add_f32 v[26:27], v[26:27], v[138:139]
    v_pk_add_f32 v[28:29], v[28:29], v[140:141]
    v_pk_add_f32 v[30:31], v[30:31], v[142:143]
.p2align 3
    v_cvt_pk_bf16_f32 v32, v16, v17
    v_cvt_pk_bf16_f32 v33, v18, v19
    v_cvt_pk_bf16_f32 v34, v20, v21
    v_cvt_pk_bf16_f32 v35, v22, v23
    v_cvt_pk_bf16_f32 v36, v24, v25
    v_cvt_pk_bf16_f32 v37, v26, v27
    v_cvt_pk_bf16_f32 v38, v28, v29
    v_cvt_pk_bf16_f32 v39, v30, v31
    v_permlane32_swap_b32 v32, v34
    v_permlane32_swap_b32 v33, v35
    v_permlane32_swap_b32 v36, v38
    v_permlane32_swap_b32 v37, v39
    buffer_store_dwordx4 v[32:35], v244, s[40:43], s60 offen offset:0
    buffer_store_dwordx4 v[36:39], v244, s[40:43], s60 offen offset:32
L_fin:
    s_endpgm
L_nog1:
.p2align 3
    v_cvt_pk_bf16_f32 v80, v80, v81
    v_cvt_pk_bf16_f32 v81, v82, v83
    v_cvt_pk_bf16_f32 v82, v84, v85
    v_cvt_pk_bf16_f32 v83, v86, v87
    v_cvt_pk_bf16_f32 v84, v88, v89
    v_cvt_pk_bf16_f32 v85, v90, v91
    v_cvt_pk_bf16_f32 v86, v92, v93
    v_cvt_pk_bf16_f32 v87, v94, v95
    ds_write_b128 v14, v[80:83]
    ds_write_b128 v14, v[84:87] offset:1024
.p2align 3
    v_max3_f32 v184, v192, v193, v194
    v_max3_f32 v185, v195, v196, v197
    v_min3_f32 v186, v192, v193, v194
    v_min3_f32 v187, v195, v196, v197
    v_max3_f32 v184, v184, v198, v199
    v_max3_f32 v185, v185, v200, v201
    v_min3_f32 v186, v186, v198, v199
    v_min3_f32 v187, v187, v200, v201
    v_max3_f32 v184, v184, v202, v203
    v_max3_f32 v185, v185, v204, v205
    v_min3_f32 v186, v186, v202, v203
    v_min3_f32 v187, v187, v204, v205
    v_max_f32 v188, v184, v185
    v_max_f32 v184, v184, v185
    v_min_f32 v189, v186, v187
    v_min_f32 v186, v186, v187
    v_mov_b32 v190, 0x3fb8aa3b
    v_permlane32_swap_b32 v184, v188
    v_permlane32_swap_b32 v186, v189
    v_max_f32 v184, v184, v188
    v_min_f32 v186, v186, v189
    v_mul_f32 v184, v190, v184
    v_mul_f32 v186, v190, v186
    v_fma_f32 v152, v192, v190, -v184
    v_fma_f32 v168, -v192, v190, v186
    v_fma_f32 v153, v193, v190, -v184
    v_fma_f32 v169, -v193, v190, v186
    v_exp_f32 v152, v152
    v_exp_f32 v168, v168
    v_fma_f32 v154, v194, v190, -v184
    v_fma_f32 v170, -v194, v190, v186
    v_exp_f32 v153, v153
    v_exp_f32 v169, v169
    v_fma_f32 v155, v195, v190, -v184
    v_fma_f32 v171, -v195, v190, v186
    v_exp_f32 v154, v154
    v_exp_f32 v170, v170
    v_fma_f32 v156, v196, v190, -v184
    v_fma_f32 v172, -v196, v190, v186
    v_exp_f32 v155, v155
    v_exp_f32 v171, v171
    v_fma_f32 v157, v197, v190, -v184
    v_fma_f32 v173, -v197, v190, v186
    v_exp_f32 v156, v156
    v_exp_f32 v172, v172
    v_fma_f32 v158, v198, v190, -v184
    v_fma_f32 v174, -v198, v190, v186
    v_exp_f32 v157, v157
    v_exp_f32 v173, v173
    v_fma_f32 v159, v199, v190, -v184
    v_fma_f32 v175, -v199, v190, v186
    v_exp_f32 v158, v158
    v_exp_f32 v174, v174
    v_fma_f32 v160, v200, v190, -v184
    v_fma_f32 v176, -v200, v190, v186
    v_exp_f32 v159, v159
    v_exp_f32 v175, v175
    v_fma_f32 v161, v201, v190, -v184
    v_fma_f32 v177, -v201, v190, v186
    v_exp_f32 v160, v160
    v_exp_f32 v176, v176
    v_fma_f32 v162, v202, v190, -v184
    v_fma_f32 v178, -v202, v190, v186
    v_exp_f32 v161, v161
    v_exp_f32 v177, v177
    v_fma_f32 v163, v203, v190, -v184
    v_fma_f32 v179, -v203, v190, v186
    v_exp_f32 v162, v162
    v_exp_f32 v178, v178
    v_fma_f32 v164, v204, v190, -v184
    v_fma_f32 v180, -v204, v190, v186
    v_exp_f32 v163, v163
    v_exp_f32 v179, v179
    v_fma_f32 v165, v205, v190, -v184
    v_fma_f32 v181, -v205, v190, v186
    v_exp_f32 v164, v164
    v_exp_f32 v180, v180
    v_exp_f32 v165, v165
    v_exp_f32 v181, v181
    v_add_f32 v192, v152, v156
    v_add_f32 v193, v153, v157
    v_add_f32 v194, v154, v158
    v_add_f32 v195, v155, v159
    v_add_f32 v196, v168, v172
    v_add_f32 v197, v169, v173
    v_add_f32 v198, v170, v174
    v_add_f32 v199, v171, v175
    v_add_f32 v192, v192, v160
    v_add_f32 v193, v193, v161
    v_add_f32 v194, v194, v162
    v_add_f32 v195, v195, v163
    v_add_f32 v196, v196, v176
    v_add_f32 v197, v197, v177
    v_add_f32 v198, v198, v178
    v_add_f32 v199, v199, v179
    v_add_f32 v192, v192, v164
    v_add_f32 v193, v193, v165
    v_add_f32 v194, v194, v195
    v_add_f32 v196, v196, v180
    v_add_f32 v197, v197, v181
    v_add_f32 v198, v198, v199
    v_add_f32 v192, v192, v193
    v_add_f32 v184, v192, v194
    v_add_f32 v188, v192, v194
    v_add_f32 v196, v196, v197
    v_add_f32 v186, v196, v198
    v_add_f32 v189, v196, v198
    v_permlane32_swap_b32 v184, v188
    s_nop 0
    v_permlane32_swap_b32 v186, v189
    v_add_f32 v184, v184, v188
    v_add_f32 v186, v186, v189
    v_rcp_f32 v184, v184
    v_rcp_f32 v186, v186
    v_mul_f32 v152, v184, v152
    v_mul_f32 v153, v184, v153
    v_mul_f32 v154, v184, v154
    v_mul_f32 v155, v184, v155
    v_mul_f32 v156, v184, v156
    v_mul_f32 v157, v184, v157
    v_mul_f32 v158, v184, v158
    v_mul_f32 v159, v184, v159
    v_mul_f32 v160, v184, v160
    v_mul_f32 v161, v184, v161
    v_mul_f32 v162, v184, v162
    v_mul_f32 v163, v184, v163
    v_mul_f32 v164, v184, v164
    v_mul_f32 v165, v184, v165
    v_mul_f32 v168, v186, v168
    v_mul_f32 v169, v186, v169
    v_mul_f32 v170, v186, v170
    v_mul_f32 v171, v186, v171
    v_mul_f32 v172, v186, v172
    v_mul_f32 v173, v186, v173
    v_mul_f32 v174, v186, v174
    v_mul_f32 v175, v186, v175
    v_mul_f32 v176, v186, v176
    v_mul_f32 v177, v186, v177
    v_mul_f32 v178, v186, v178
    v_mul_f32 v179, v186, v179
    v_mul_f32 v180, v186, v180
    v_mul_f32 v181, v186, v181
.p2align 3
    v_cvt_pk_bf16_f32 v192, v152, v153
    v_cvt_pk_bf16_f32 v193, v154, v155
    v_cvt_pk_bf16_f32 v194, v156, v157
    v_cvt_pk_bf16_f32 v195, v158, v159
    v_cvt_pk_bf16_f32 v196, v160, v161
    v_cvt_pk_bf16_f32 v197, v162, v163
    v_cvt_pk_bf16_f32 v198, v164, v165
.p2align 3
    v_cvt_pk_bf16_f32 v200, v168, v169
    v_cvt_pk_bf16_f32 v201, v170, v171
    v_cvt_pk_bf16_f32 v202, v172, v173
    v_cvt_pk_bf16_f32 v203, v174, v175
    v_cvt_pk_bf16_f32 v204, v176, v177
    v_cvt_pk_bf16_f32 v205, v178, v179
    v_cvt_pk_bf16_f32 v206, v180, v181
    v_mov_b32 v199, 0
    v_mov_b32 v207, 0
    ds_write_b64 v11, v[192:193]
    v_xor_b32 v153, 16, v11
    ds_write_b64 v153, v[194:195]
    v_xor_b32 v154, 32, v11
    ds_write_b64 v154, v[196:197]
    v_xor_b32 v155, 48, v11
    ds_write_b64 v155, v[198:199]
    v_xor_b32 v156, 64, v11
    ds_write_b64 v156, v[200:201]
    v_xor_b32 v157, 80, v11
    ds_write_b64 v157, v[202:203]
    v_xor_b32 v158, 96, v11
    ds_write_b64 v158, v[204:205]
    v_xor_b32 v159, 112, v11
    ds_write_b64 v159, v[206:207]
    v_and_b32 v243, 1, v0
    v_lshlrev_b32 v243, 7, v243
    s_lshl_b32 s67, s55, 8
    s_add_u32 s67, s67, 32768
    s_waitcnt lgkmcnt(0)
    s_barrier
    ds_read_b64_tr_b16 v[152:153], v12 offset:0
    ds_read_b64_tr_b16 v[154:155], v13 offset:1024
    ds_read_b128 v[168:171], v15 offset:0
    ds_read_b64_tr_b16 v[156:157], v12 offset:2048
    ds_read_b64_tr_b16 v[158:159], v13 offset:3072
    ds_read_b128 v[172:175], v15 offset:1024
    ds_read_b64_tr_b16 v[160:161], v12 offset:4096
    ds_read_b64_tr_b16 v[162:163], v13 offset:5120
    ds_read_b128 v[176:179], v15 offset:2048
    ds_read_b64_tr_b16 v[164:165], v12 offset:6144
    ds_read_b64_tr_b16 v[166:167], v13 offset:7168
    ds_read_b128 v[180:183], v15 offset:3072
    s_waitcnt lgkmcnt(9)
    v_mfma_f32_32x32x16_bf16 v[192:207], v[152:155], v[168:171], 0
    s_waitcnt lgkmcnt(6)
    v_mfma_f32_32x32x16_bf16 v[192:207], v[156:159], v[172:175], v[192:207]
    s_waitcnt lgkmcnt(3)
    v_mfma_f32_32x32x16_bf16 v[192:207], v[160:163], v[176:179], v[192:207]
    s_waitcnt lgkmcnt(0)
    v_mfma_f32_32x32x16_bf16 v[192:207], v[164:167], v[180:183], v[192:207]
    ds_read_b64_tr_b16 v[152:153], v12 offset:8192
    ds_read_b64_tr_b16 v[154:155], v13 offset:9216
    ds_read_b128 v[168:171], v15 offset:4096
    ds_read_b64_tr_b16 v[156:157], v12 offset:10240
    ds_read_b64_tr_b16 v[158:159], v13 offset:11264
    ds_read_b128 v[172:175], v15 offset:5120
    ds_read_b64_tr_b16 v[160:161], v12 offset:12288
    ds_read_b64_tr_b16 v[162:163], v13 offset:13312
    ds_read_b128 v[176:179], v15 offset:6144
    ds_read_b64_tr_b16 v[164:165], v12 offset:14336
    ds_read_b64_tr_b16 v[166:167], v13 offset:15360
    ds_read_b128 v[180:183], v15 offset:7168
    s_waitcnt lgkmcnt(9)
    v_mfma_f32_32x32x16_bf16 v[192:207], v[152:155], v[168:171], v[192:207]
    s_waitcnt lgkmcnt(6)
    v_mfma_f32_32x32x16_bf16 v[192:207], v[156:159], v[172:175], v[192:207]
    s_waitcnt lgkmcnt(3)
    v_mfma_f32_32x32x16_bf16 v[192:207], v[160:163], v[176:179], v[192:207]
    s_waitcnt lgkmcnt(0)
    v_mfma_f32_32x32x16_bf16 v[192:207], v[164:167], v[180:183], v[192:207]
    s_nop 11
    buffer_store_dwordx4 v[192:195], v1, s[44:47], s65 offen sc1
    buffer_store_dwordx4 v[196:199], v1, s[44:47], s65 offen offset:1024 sc1
    s_cmp_eq_u32 s59, 0
    s_cbranch_scc1 L_nopre
    v_mul_u32_u24 v2, 4096, v8
    v_add_u32 v2, v2, v9
    v_add_u32 v3, 31744, v2
    s_mul_i32 s68, s48, 1835008
    s_lshl_b32 s69, s57, 7
    s_add_u32 s68, s68, s69
    s_mul_i32 s4, s58, 4
    s_sub_u32 s4, 28, s4
    s_mul_i32 s1, s58, 262144
    s_add_u32 s1, s1, s68
    s_sub_u32 s3, s1, 1835008
    s_add_u32 m0, s72, 0
    s_cmp_gt_u32 s4, 0
    s_cselect_b32 s75, s1, s3
    buffer_load_dwordx4 v2, s[32:35], s75 offen lds
    buffer_load_dwordx4 v3, s[32:35], s75 offen offset:1024 lds
    s_add_u32 m0, s72, 2048
    s_cmp_gt_u32 s4, 1
    s_cselect_b32 s75, s1, s3
    s_add_u32 s75, s75, 65536
    buffer_load_dwordx4 v2, s[32:35], s75 offen lds
    buffer_load_dwordx4 v3, s[32:35], s75 offen offset:1024 lds
    s_add_u32 m0, s72, 4096
    s_cmp_gt_u32 s4, 2
    s_cselect_b32 s75, s1, s3
    s_add_u32 s75, s75, 131072
    buffer_load_dwordx4 v2, s[32:35], s75 offen lds
    buffer_load_dwordx4 v3, s[32:35], s75 offen offset:1024 lds
    s_add_u32 m0, s72, 6144
    s_cmp_gt_u32 s4, 3
    s_cselect_b32 s75, s1, s3
    s_add_u32 s75, s75, 196608
    buffer_load_dwordx4 v2, s[32:35], s75 offen lds
    buffer_load_dwordx4 v3, s[32:35], s75 offen offset:1024 lds
    s_waitcnt vmcnt(8)
    s_branch L_pre2
L_nopre:
    s_waitcnt vmcnt(0)
L_pre2:
    s_barrier
    s_cmp_lg_u32 s48, 1
    s_cbranch_scc1 L_wf_20
    v_mov_b32 v249, s51
    v_mov_b32 v248, 0
    s_mov_b64 exec, 1
    buffer_store_dword v249, v248, s[44:47], s64 offen sc1
    s_mov_b64 exec, -1
L_wf_20:
    s_cmp_eq_u32 s59, 0
    s_cbranch_scc0 L_fill
    v_and_b32 v11, 15, v0
    v_lshlrev_b32 v11, 7, v11
    s_sub_u32 s60, s2, 224
    s_lshr_b32 s61, s60, 1
    s_lshl_b32 s66, s61, 11
    s_add_u32 s66, s66, 262144
    s_lshl_b32 s62, s61, 17
    s_and_b32 s63, s60, 1
    s_lshl_b32 s63, s63, 12
    s_add_u32 s62, s62, s63
    s_lshr_b32 s63, s48, 1
    s_lshl_b32 s63, s63, 11
    s_add_u32 s62, s62, s63
    s_and_b32 s63, s48, 1
    s_lshl_b32 s63, s63, 9
    s_add_u32 s62, s62, s63
    s_add_u32 s62, s62, 11534336
    v_lshlrev_b32 v12, 10, v240
    v_lshl_add_u32 v12, v241, 4, v12
    s_mov_b32 s68, 0
    s_mov_b32 s74, 200000
L_rpoll:
    buffer_load_dword v250, v11, s[44:47], s66 offen sc1
    s_waitcnt vmcnt(0)
    v_cmp_eq_u32 vcc, s51, v250
    s_sub_u32 s74, s74, 1
    s_cmp_eq_u32 s74, 0
    s_cselect_b32 s69, 0xffff, vcc_lo
    s_andn2_b32 s69, s69, s68
    s_and_b32 s69, s69, 0xffff
    s_cbranch_scc1 L_rnew
    s_sleep 2
    s_branch L_rpoll
L_rnew:
    s_or_b32 s68, s68, s69
    s_bitcmp1_b32 s69, 0
    s_cbranch_scc0 L_rs0
    s_add_u32 s63, s62, 0
    buffer_load_dwordx4 v[96:99], v12, s[44:47], s63 offen sc1
L_rs0:
    s_bitcmp1_b32 s69, 1
    s_cbranch_scc0 L_rs1
    s_add_u32 s63, s62, 8192
    buffer_load_dwordx4 v[100:103], v12, s[44:47], s63 offen sc1
L_rs1:
    s_bitcmp1_b32 s69, 2
    s_cbranch_scc0 L_rs2
    s_add_u32 s63, s62, 16384
    buffer_load_dwordx4 v[104:107], v12, s[44:47], s63 offen sc1
L_rs2:
    s_bitcmp1_b32 s69, 3
    s_cbranch_scc0 L_rs3
    s_add_u32 s63, s62, 24576
    buffer_load_dwordx4 v[108:111], v12, s[44:47], s63 offen sc1
L_rs3:
    s_bitcmp1_b32 s69, 4
    s_cbranch_scc0 L_rs4
    s_add_u32 s63, s62, 32768
    buffer_load_dwordx4 v[112:115], v12, s[44:47], s63 offen sc1
L_rs4:
    s_bitcmp1_b32 s69, 5
    s_cbranch_scc0 L_rs5
    s_add_u32 s63, s62, 40960
    buffer_load_dwordx4 v[116:119], v12, s[44:47], s63 offen sc1
L_rs5:
    s_bitcmp1_b32 s69, 6
    s_cbranch_scc0 L_rs6
    s_add_u32 s63, s62, 49152
    buffer_load_dwordx4 v[120:123], v12, s[44:47], s63 offen sc1
L_rs6:
    s_bitcmp1_b32 s69, 7
    s_cbranch_scc0 L_rs7
    s_add_u32 s63, s62, 57344
    buffer_load_dwordx4 v[124:127], v12, s[44:47], s63 offen sc1
L_rs7:
    s_bitcmp1_b32 s69, 8
    s_cbranch_scc0 L_rs8
    s_add_u32 s63, s62, 65536
    buffer_load_dwordx4 v[128:131], v12, s[44:47], s63 offen sc1
L_rs8:
    s_bitcmp1_b32 s69, 9
    s_cbranch_scc0 L_rs9
    s_add_u32 s63, s62, 73728
    buffer_load_dwordx4 v[132:135], v12, s[44:47], s63 offen sc1
L_rs9:
    s_bitcmp1_b32 s69, 10
    s_cbranch_scc0 L_rs10
    s_add_u32 s63, s62, 81920
    buffer_load_dwordx4 v[136:139], v12, s[44:47], s63 offen sc1
L_rs10:
    s_bitcmp1_b32 s69, 11
    s_cbranch_scc0 L_rs11
    s_add_u32 s63, s62, 90112
    buffer_load_dwordx4 v[140:143], v12, s[44:47], s63 offen sc1
L_rs11:
    s_bitcmp1_b32 s69, 12
    s_cbranch_scc0 L_rs12
    s_add_u32 s63, s62, 98304
    buffer_load_dwordx4 v[144:147], v12, s[44:47], s63 offen sc1
L_rs12:
    s_bitcmp1_b32 s69, 13
    s_cbranch_scc0 L_rs13
    s_add_u32 s63, s62, 106496
    buffer_load_dwordx4 v[148:151], v12, s[44:47], s63 offen sc1
L_rs13:
    s_bitcmp1_b32 s69, 14
    s_cbranch_scc0 L_rs14
    s_add_u32 s63, s62, 114688
    buffer_load_dwordx4 v[152:155], v12, s[44:47], s63 offen sc1
L_rs14:
    s_bitcmp1_b32 s69, 15
    s_cbranch_scc0 L_rs15
    s_add_u32 s63, s62, 122880
    buffer_load_dwordx4 v[156:159], v12, s[44:47], s63 offen sc1
L_rs15:
    s_cmp_lg_u32 s68, 0xffff
    s_cbranch_scc1 L_rpoll
    s_lshl_b32 s62, s60, 11
    s_lshl_b32 s63, s48, 9
    s_add_u32 s62, s62, s63
    s_add_u32 s62, s62, 65536
    s_lshl_b32 s63, s60, 7
    s_add_u32 s63, s63, 32768
    s_waitcnt vmcnt(0)
.p2align 3
    v_pk_add_f32 v[96:97], v[96:97], v[128:129]
    v_pk_add_f32 v[98:99], v[98:99], v[130:131]
    v_pk_add_f32 v[100:101], v[100:101], v[132:133]
    v_pk_add_f32 v[102:103], v[102:103], v[134:135]
    v_pk_add_f32 v[104:105], v[104:105], v[136:137]
    v_pk_add_f32 v[106:107], v[106:107], v[138:139]
    v_pk_add_f32 v[108:109], v[108:109], v[140:141]
    v_pk_add_f32 v[110:111], v[110:111], v[142:143]
    v_pk_add_f32 v[112:113], v[112:113], v[144:145]
    v_pk_add_f32 v[114:115], v[114:115], v[146:147]
    v_pk_add_f32 v[116:117], v[116:117], v[148:149]
    v_pk_add_f32 v[118:119], v[118:119], v[150:151]
    v_pk_add_f32 v[120:121], v[120:121], v[152:153]
    v_pk_add_f32 v[122:123], v[122:123], v[154:155]
    v_pk_add_f32 v[124:125], v[124:125], v[156:157]
    v_pk_add_f32 v[126:127], v[126:127], v[158:159]
    v_pk_add_f32 v[96:97], v[96:97], v[112:113]
    v_pk_add_f32 v[98:99], v[98:99], v[114:115]
    v_pk_add_f32 v[100:101], v[100:101], v[116:117]
    v_pk_add_f32 v[102:103], v[102:103], v[118:119]
    v_pk_add_f32 v[104:105], v[104:105], v[120:121]
    v_pk_add_f32 v[106:107], v[106:107], v[122:123]
    v_pk_add_f32 v[108:109], v[108:109], v[124:125]
    v_pk_add_f32 v[110:111], v[110:111], v[126:127]
    v_pk_add_f32 v[96:97], v[96:97], v[104:105]
    v_pk_add_f32 v[98:99], v[98:99], v[106:107]
    v_pk_add_f32 v[100:101], v[100:101], v[108:109]
    v_pk_add_f32 v[102:103], v[102:103], v[110:111]
    v_pk_add_f32 v[96:97], v[96:97], v[100:101]
    v_pk_add_f32 v[98:99], v[98:99], v[102:103]
    v_cvt_pk_bf16_f32 v100, v96, v97
    v_cvt_pk_bf16_f32 v101, v98, v99
    v_mov_b32 v104, v100
    v_mov_b32 v105, v101
    s_nop 0
    v_permlane32_swap_b32 v104, v102
    v_permlane32_swap_b32 v105, v103
    v_cmp_eq_u32 vcc, 29, v0
    v_mov_b32 v104, 0x3f803f80
    s_nop 0
    v_cndmask_b32 v100, v100, v104, vcc
    v_cndmask_b32 v101, v101, v104, vcc
    v_cndmask_b32 v102, v102, v104, vcc
    v_cndmask_b32 v103, v103, v104, vcc
    s_mov_b32 exec_hi, 0
    buffer_store_dwordx4 v[100:103], v1, s[44:47], s62 offen sc1
    s_mov_b64 exec, -1
    s_waitcnt vmcnt(0)
    s_barrier
    s_cmp_lg_u32 s48, 0
    s_cbranch_scc1 L_wf_21
    v_mov_b32 v249, s51
    v_mov_b32 v248, 0
    s_mov_b64 exec, 1
    buffer_store_dword v249, v248, s[44:47], s63 offen sc1
    s_mov_b64 exec, -1
L_wf_21:
    s_mov_b32 s22, 401408
    s_sub_u32 s60, s50, 28
    s_lshl_b32 s60, s60, 2
    s_add_u32 s60, s60, s48
    s_mul_i32 s60, s60, 25088
    v_lshl_add_u32 v13, v0, 7, s60
    buffer_load_dword v16, v13, s[20:23], 0 offen
    v_add_u32 v13, 0x2000, v13
    buffer_load_dword v17, v13, s[20:23], 0 offen
    v_add_u32 v13, 0x2000, v13
    buffer_load_dword v18, v13, s[20:23], 0 offen
    v_add_u32 v13, 0x2000, v13
    s_mov_b64 exec, 15
    buffer_load_dword v19, v13, s[20:23], 0 offen
    s_mov_b64 exec, -1
    s_branch L_lightq
L_fill:
    s_add_u32 m0, s72, 8192
    s_cmp_gt_u32 s4, 4
    s_cselect_b32 s75, s1, s3
    s_add_u32 s75, s75, 262144
    buffer_load_dwordx4 v2, s[32:35], s75 offen lds
    buffer_load_dwordx4 v3, s[32:35], s75 offen offset:1024 lds
    s_add_u32 m0, s72, 10240
    s_cmp_gt_u32 s4, 5
    s_cselect_b32 s75, s1, s3
    s_add_u32 s75, s75, 327680
    buffer_load_dwordx4 v2, s[32:35], s75 offen lds
    buffer_load_dwordx4 v3, s[32:35], s75 offen offset:1024 lds
    s_add_u32 m0, s72, 12288
    s_cmp_gt_u32 s4, 6
    s_cselect_b32 s75, s1, s3
    s_add_u32 s75, s75, 393216
    buffer_load_dwordx4 v2, s[32:35], s75 offen lds
    buffer_load_dwordx4 v3, s[32:35], s75 offen offset:1024 lds
    s_add_u32 m0, s72, 14336
    s_cmp_gt_u32 s4, 7
    s_cselect_b32 s75, s1, s3
    s_add_u32 s75, s75, 458752
    buffer_load_dwordx4 v2, s[32:35], s75 offen lds
    buffer_load_dwordx4 v3, s[32:35], s75 offen offset:1024 lds
    v_lshl_add_u32 v4, v240, 9, v10
    s_lshr_b32 s69, s48, 0
    s_and_b32 s69, s69, 1
    s_lshl_b32 s69, s69, 6
    v_xor_b32 v4, s69, v4
    v_xor_b32 v5, 64, v4
    s_waitcnt vmcnt(14)
    ds_read_b64_tr_b16 a[0:1], v4 offset:0
    ds_read_b64_tr_b16 a[2:3], v4 offset:1024
    ds_read_b64_tr_b16 a[4:5], v5 offset:0
    ds_read_b64_tr_b16 a[6:7], v5 offset:1024
    s_add_u32 m0, s72, 16384
    s_cmp_gt_u32 s4, 8
    s_cselect_b32 s75, s1, s3
    s_add_u32 s75, s75, 524288
    buffer_load_dwordx4 v2, s[32:35], s75 offen lds
    buffer_load_dwordx4 v3, s[32:35], s75 offen offset:1024 lds
    s_waitcnt vmcnt(14)
    ds_read_b64_tr_b16 a[8:9], v4 offset:2048
    ds_read_b64_tr_b16 a[10:11], v4 offset:3072
    ds_read_b64_tr_b16 a[12:13], v5 offset:2048
    ds_read_b64_tr_b16 a[14:15], v5 offset:3072
    s_add_u32 m0, s72, 18432
    s_cmp_gt_u32 s4, 9
    s_cselect_b32 s75, s1, s3
    s_add_u32 s75, s75, 589824
    buffer_load_dwordx4 v2, s[32:35], s75 offen lds
    buffer_load_dwordx4 v3, s[32:35], s75 offen offset:1024 lds
    s_waitcnt vmcnt(14)
    ds_read_b64_tr_b16 a[16:17], v4 offset:4096
    ds_read_b64_tr_b16 a[18:19], v4 offset:5120
    ds_read_b64_tr_b16 a[20:21], v5 offset:4096
    ds_read_b64_tr_b16 a[22:23], v5 offset:5120
    s_add_u32 m0, s72, 20480
    s_cmp_gt_u32 s4, 10
    s_cselect_b32 s75, s1, s3
    s_add_u32 s75, s75, 655360
    buffer_load_dwordx4 v2, s[32:35], s75 offen lds
    buffer_load_dwordx4 v3, s[32:35], s75 offen offset:1024 lds
    s_waitcnt vmcnt(14)
    ds_read_b64_tr_b16 a[24:25], v4 offset:6144
    ds_read_b64_tr_b16 a[26:27], v4 offset:7168
    ds_read_b64_tr_b16 a[28:29], v5 offset:6144
    ds_read_b64_tr_b16 a[30:31], v5 offset:7168
    s_add_u32 m0, s72, 22528
    s_cmp_gt_u32 s4, 11
    s_cselect_b32 s75, s1, s3
    s_add_u32 s75, s75, 720896
    buffer_load_dwordx4 v2, s[32:35], s75 offen lds
    buffer_load_dwordx4 v3, s[32:35], s75 offen offset:1024 lds
    s_waitcnt vmcnt(14)
    ds_read_b64_tr_b16 a[32:33], v4 offset:8192
    ds_read_b64_tr_b16 a[34:35], v4 offset:9216
    ds_read_b64_tr_b16 a[36:37], v5 offset:8192
    ds_read_b64_tr_b16 a[38:39], v5 offset:9216
    s_waitcnt lgkmcnt(15)
    s_add_u32 m0, s72, 0
    s_cmp_gt_u32 s4, 12
    s_cselect_b32 s75, s1, s3
    s_add_u32 s75, s75, 786432
    buffer_load_dwordx4 v2, s[32:35], s75 offen lds
    buffer_load_dwordx4 v3, s[32:35], s75 offen offset:1024 lds
    s_waitcnt vmcnt(14)
    ds_read_b64_tr_b16 a[40:41], v4 offset:10240
    ds_read_b64_tr_b16 a[42:43], v4 offset:11264
    ds_read_b64_tr_b16 a[44:45], v5 offset:10240
    ds_read_b64_tr_b16 a[46:47], v5 offset:11264
    s_waitcnt lgkmcnt(15)
    s_add_u32 m0, s72, 2048
    s_cmp_gt_u32 s4, 13
    s_cselect_b32 s75, s1, s3
    s_add_u32 s75, s75, 851968
    buffer_load_dwordx4 v2, s[32:35], s75 offen lds
    buffer_load_dwordx4 v3, s[32:35], s75 offen offset:1024 lds
    s_waitcnt vmcnt(14)
    ds_read_b64_tr_b16 a[48:49], v4 offset:12288
    ds_read_b64_tr_b16 a[50:51], v4 offset:13312
    ds_read_b64_tr_b16 a[52:53], v5 offset:12288
    ds_read_b64_tr_b16 a[54:55], v5 offset:13312
    s_waitcnt lgkmcnt(15)
    s_add_u32 m0, s72, 4096
    s_cmp_gt_u32 s4, 14
    s_cselect_b32 s75, s1, s3
    s_add_u32 s75, s75, 917504
    buffer_load_dwordx4 v2, s[32:35], s75 offen lds
    buffer_load_dwordx4 v3, s[32:35], s75 offen offset:1024 lds
    s_waitcnt vmcnt(14)
    ds_read_b64_tr_b16 a[56:57], v4 offset:14336
    ds_read_b64_tr_b16 a[58:59], v4 offset:15360
    ds_read_b64_tr_b16 a[60:61], v5 offset:14336
    ds_read_b64_tr_b16 a[62:63], v5 offset:15360
    s_waitcnt lgkmcnt(15)
    s_add_u32 m0, s72, 6144
    s_cmp_gt_u32 s4, 15
    s_cselect_b32 s75, s1, s3
    s_add_u32 s75, s75, 983040
    buffer_load_dwordx4 v2, s[32:35], s75 offen lds
    buffer_load_dwordx4 v3, s[32:35], s75 offen offset:1024 lds
    s_waitcnt vmcnt(14)
    ds_read_b64_tr_b16 a[64:65], v4 offset:16384
    ds_read_b64_tr_b16 a[66:67], v4 offset:17408
    ds_read_b64_tr_b16 a[68:69], v5 offset:16384
    ds_read_b64_tr_b16 a[70:71], v5 offset:17408
    s_waitcnt lgkmcnt(15)
    s_add_u32 m0, s72, 8192
    s_cmp_gt_u32 s4, 16
    s_cselect_b32 s75, s1, s3
    s_add_u32 s75, s75, 1048576
    buffer_load_dwordx4 v2, s[32:35], s75 offen lds
    buffer_load_dwordx4 v3, s[32:35], s75 offen offset:1024 lds
    s_waitcnt vmcnt(14)
    ds_read_b64_tr_b16 a[72:73], v4 offset:18432
    ds_read_b64_tr_b16 a[74:75], v4 offset:19456
    ds_read_b64_tr_b16 a[76:77], v5 offset:18432
    ds_read_b64_tr_b16 a[78:79], v5 offset:19456
    s_waitcnt lgkmcnt(15)
    s_add_u32 m0, s72, 10240
    s_cmp_gt_u32 s4, 17
    s_cselect_b32 s75, s1, s3
    s_add_u32 s75, s75, 1114112
    buffer_load_dwordx4 v2, s[32:35], s75 offen lds
    buffer_load_dwordx4 v3, s[32:35], s75 offen offset:1024 lds
    s_waitcnt vmcnt(14)
    ds_read_b64_tr_b16 a[80:81], v4 offset:20480
    ds_read_b64_tr_b16 a[82:83], v4 offset:21504
    ds_read_b64_tr_b16 a[84:85], v5 offset:20480
    ds_read_b64_tr_b16 a[86:87], v5 offset:21504
    s_waitcnt lgkmcnt(15)
    s_add_u32 m0, s72, 12288
    s_cmp_gt_u32 s4, 18
    s_cselect_b32 s75, s1, s3
    s_add_u32 s75, s75, 1179648
    buffer_load_dwordx4 v2, s[32:35], s75 offen lds
    buffer_load_dwordx4 v3, s[32:35], s75 offen offset:1024 lds
    s_waitcnt vmcnt(14)
    ds_read_b64_tr_b16 a[88:89], v4 offset:22528
    ds_read_b64_tr_b16 a[90:91], v4 offset:23552
    ds_read_b64_tr_b16 a[92:93], v5 offset:22528
    ds_read_b64_tr_b16 a[94:95], v5 offset:23552
    s_waitcnt lgkmcnt(15)
    s_add_u32 m0, s72, 14336
    s_cmp_gt_u32 s4, 19
    s_cselect_b32 s75, s1, s3
    s_add_u32 s75, s75, 1245184
    buffer_load_dwordx4 v2, s[32:35], s75 offen lds
    buffer_load_dwordx4 v3, s[32:35], s75 offen offset:1024 lds
    s_waitcnt vmcnt(14)
    ds_read_b64_tr_b16 a[96:97], v4 offset:0
    ds_read_b64_tr_b16 a[98:99], v4 offset:1024
    ds_read_b64_tr_b16 a[100:101], v5 offset:0
    ds_read_b64_tr_b16 a[102:103], v5 offset:1024
    s_waitcnt lgkmcnt(15)
    s_add_u32 m0, s72, 16384
    s_cmp_gt_u32 s4, 20
    s_cselect_b32 s75, s1, s3
    s_add_u32 s75, s75, 1310720
    buffer_load_dwordx4 v2, s[32:35], s75 offen lds
    buffer_load_dwordx4 v3, s[32:35], s75 offen offset:1024 lds
    s_waitcnt vmcnt(14)
    ds_read_b64_tr_b16 a[104:105], v4 offset:2048
    ds_read_b64_tr_b16 a[106:107], v4 offset:3072
    ds_read_b64_tr_b16 a[108:109], v5 offset:2048
    ds_read_b64_tr_b16 a[110:111], v5 offset:3072
    s_waitcnt lgkmcnt(15)
    s_add_u32 m0, s72, 18432
    s_cmp_gt_u32 s4, 21
    s_cselect_b32 s75, s1, s3
    s_add_u32 s75, s75, 1376256
    buffer_load_dwordx4 v2, s[32:35], s75 offen lds
    buffer_load_dwordx4 v3, s[32:35], s75 offen offset:1024 lds
    s_waitcnt vmcnt(14)
    ds_read_b64_tr_b16 a[112:113], v4 offset:4096
    ds_read_b64_tr_b16 a[114:115], v4 offset:5120
    ds_read_b64_tr_b16 a[116:117], v5 offset:4096
    ds_read_b64_tr_b16 a[118:119], v5 offset:5120
    s_waitcnt lgkmcnt(15)
    s_add_u32 m0, s72, 20480
    s_cmp_gt_u32 s4, 22
    s_cselect_b32 s75, s1, s3
    s_add_u32 s75, s75, 1441792
    buffer_load_dwordx4 v2, s[32:35], s75 offen lds
    buffer_load_dwordx4 v3, s[32:35], s75 offen offset:1024 lds
    s_waitcnt vmcnt(14)
    ds_read_b64_tr_b16 a[120:121], v4 offset:6144
    ds_read_b64_tr_b16 a[122:123], v4 offset:7168
    ds_read_b64_tr_b16 a[124:125], v5 offset:6144
    ds_read_b64_tr_b16 a[126:127], v5 offset:7168
    s_waitcnt lgkmcnt(15)
    s_add_u32 m0, s72, 22528
    s_cmp_gt_u32 s4, 23
    s_cselect_b32 s75, s1, s3
    s_add_u32 s75, s75, 1507328
    buffer_load_dwordx4 v2, s[32:35], s75 offen lds
    buffer_load_dwordx4 v3, s[32:35], s75 offen offset:1024 lds
    s_waitcnt vmcnt(14)
    ds_read_b64_tr_b16 a[128:129], v4 offset:8192
    ds_read_b64_tr_b16 a[130:131], v4 offset:9216
    ds_read_b64_tr_b16 a[132:133], v5 offset:8192
    ds_read_b64_tr_b16 a[134:135], v5 offset:9216
    s_waitcnt lgkmcnt(15)
    s_add_u32 m0, s72, 0
    s_cmp_gt_u32 s4, 24
    s_cselect_b32 s75, s1, s3
    s_add_u32 s75, s75, 1572864
    buffer_load_dwordx4 v2, s[32:35], s75 offen lds
    buffer_load_dwordx4 v3, s[32:35], s75 offen offset:1024 lds
    s_waitcnt vmcnt(14)
    ds_read_b64_tr_b16 a[136:137], v4 offset:10240
    ds_read_b64_tr_b16 a[138:139], v4 offset:11264
    ds_read_b64_tr_b16 a[140:141], v5 offset:10240
    ds_read_b64_tr_b16 a[142:143], v5 offset:11264
    s_waitcnt lgkmcnt(15)
    s_add_u32 m0, s72, 2048
    s_cmp_gt_u32 s4, 25
    s_cselect_b32 s75, s1, s3
    s_add_u32 s75, s75, 1638400
    buffer_load_dwordx4 v2, s[32:35], s75 offen lds
    buffer_load_dwordx4 v3, s[32:35], s75 offen offset:1024 lds
    s_waitcnt vmcnt(14)
    ds_read_b64_tr_b16 a[144:145], v4 offset:12288
    ds_read_b64_tr_b16 a[146:147], v4 offset:13312
    ds_read_b64_tr_b16 a[148:149], v5 offset:12288
    ds_read_b64_tr_b16 a[150:151], v5 offset:13312
    s_waitcnt lgkmcnt(15)
    s_add_u32 m0, s72, 4096
    s_cmp_gt_u32 s4, 26
    s_cselect_b32 s75, s1, s3
    s_add_u32 s75, s75, 1703936
    buffer_load_dwordx4 v2, s[32:35], s75 offen lds
    buffer_load_dwordx4 v3, s[32:35], s75 offen offset:1024 lds
    s_waitcnt vmcnt(14)
    ds_read_b64_tr_b16 a[152:153], v4 offset:14336
    ds_read_b64_tr_b16 a[154:155], v4 offset:15360
    ds_read_b64_tr_b16 a[156:157], v5 offset:14336
    ds_read_b64_tr_b16 a[158:159], v5 offset:15360
    s_waitcnt lgkmcnt(15)
    s_add_u32 m0, s72, 6144
    s_cmp_gt_u32 s4, 27
    s_cselect_b32 s75, s1, s3
    s_add_u32 s75, s75, 1769472
    buffer_load_dwordx4 v2, s[32:35], s75 offen lds
    buffer_load_dwordx4 v3, s[32:35], s75 offen offset:1024 lds
    s_waitcnt vmcnt(14)
    ds_read_b64_tr_b16 a[160:161], v4 offset:16384
    ds_read_b64_tr_b16 a[162:163], v4 offset:17408
    ds_read_b64_tr_b16 a[164:165], v5 offset:16384
    ds_read_b64_tr_b16 a[166:167], v5 offset:17408
    s_waitcnt vmcnt(12)
    ds_read_b64_tr_b16 a[168:169], v4 offset:18432
    ds_read_b64_tr_b16 a[170:171], v4 offset:19456
    ds_read_b64_tr_b16 a[172:173], v5 offset:18432
    ds_read_b64_tr_b16 a[174:175], v5 offset:19456
    s_waitcnt vmcnt(10)
    ds_read_b64_tr_b16 a[176:177], v4 offset:20480
    ds_read_b64_tr_b16 a[178:179], v4 offset:21504
    ds_read_b64_tr_b16 a[180:181], v5 offset:20480
    ds_read_b64_tr_b16 a[182:183], v5 offset:21504
    s_waitcnt vmcnt(8)
    ds_read_b64_tr_b16 a[184:185], v4 offset:22528
    ds_read_b64_tr_b16 a[186:187], v4 offset:23552
    ds_read_b64_tr_b16 a[188:189], v5 offset:22528
    ds_read_b64_tr_b16 a[190:191], v5 offset:23552
    s_waitcnt vmcnt(6)
    ds_read_b64_tr_b16 a[192:193], v4 offset:0
    ds_read_b64_tr_b16 a[194:195], v4 offset:1024
    ds_read_b64_tr_b16 a[196:197], v5 offset:0
    ds_read_b64_tr_b16 a[198:199], v5 offset:1024
    v_mul_u32_u24 v2, 896, v8
    v_add_u32 v2, v2, v9
    v_add_u32 v3, 6144, v2
    s_mul_i32 s1, s48, 100352
    s_lshl_b32 s69, s58, 7
    s_add_u32 s1, s1, s69
    s_waitcnt lgkmcnt(0)
    s_add_u32 m0, s72, 0
    s_add_u32 s75, s1, 0
    buffer_load_dwordx4 v2, s[20:23], s75 offen lds
    buffer_load_dwordx4 v3, s[20:23], s75 offen offset:1024 lds
    s_waitcnt vmcnt(6)
    ds_read_b64_tr_b16 a[200:201], v4 offset:2048
    ds_read_b64_tr_b16 a[202:203], v4 offset:3072
    ds_read_b64_tr_b16 a[204:205], v5 offset:2048
    ds_read_b64_tr_b16 a[206:207], v5 offset:3072
    s_waitcnt lgkmcnt(0)
    s_add_u32 m0, s72, 2048
    s_add_u32 s75, s1, 14336
    buffer_load_dwordx4 v2, s[20:23], s75 offen lds
    buffer_load_dwordx4 v3, s[20:23], s75 offen offset:1024 lds
    s_waitcnt vmcnt(6)
    ds_read_b64_tr_b16 a[208:209], v4 offset:4096
    ds_read_b64_tr_b16 a[210:211], v4 offset:5120
    ds_read_b64_tr_b16 a[212:213], v5 offset:4096
    ds_read_b64_tr_b16 a[214:215], v5 offset:5120
    s_waitcnt lgkmcnt(0)
    s_add_u32 m0, s72, 4096
    s_add_u32 s75, s1, 25088
    buffer_load_dwordx4 v2, s[20:23], s75 offen lds
    buffer_load_dwordx4 v3, s[20:23], s75 offen offset:1024 lds
    s_waitcnt vmcnt(6)
    ds_read_b64_tr_b16 a[216:217], v4 offset:6144
    ds_read_b64_tr_b16 a[218:219], v4 offset:7168
    ds_read_b64_tr_b16 a[220:221], v5 offset:6144
    ds_read_b64_tr_b16 a[222:223], v5 offset:7168
    s_waitcnt lgkmcnt(0)
    s_add_u32 m0, s72, 6144
    s_add_u32 s75, s1, 39424
    buffer_load_dwordx4 v2, s[20:23], s75 offen lds
    buffer_load_dwordx4 v3, s[20:23], s75 offen offset:1024 lds
    s_add_u32 m0, s72, 8192
    s_add_u32 s75, s1, 50176
    buffer_load_dwordx4 v2, s[20:23], s75 offen lds
    buffer_load_dwordx4 v3, s[20:23], s75 offen offset:1024 lds
    s_add_u32 m0, s72, 10240
    s_add_u32 s75, s1, 64512
    buffer_load_dwordx4 v2, s[20:23], s75 offen lds
    buffer_load_dwordx4 v3, s[20:23], s75 offen offset:1024 lds
    s_add_u32 m0, s72, 12288
    s_add_u32 s75, s1, 75264
    buffer_load_dwordx4 v2, s[20:23], s75 offen lds
    buffer_load_dwordx4 v3, s[20:23], s75 offen offset:1024 lds
    s_add_u32 m0, s72, 14336
    s_add_u32 s75, s1, 89600
    buffer_load_dwordx4 v2, s[20:23], s75 offen lds
    buffer_load_dwordx4 v3, s[20:23], s75 offen offset:1024 lds
L_lightq:
.p2align 3
    v_max3_f32 v184, v208, v209, v210
    v_max3_f32 v185, v211, v212, v213
    v_min3_f32 v186, v208, v209, v210
    v_min3_f32 v187, v211, v212, v213
    v_max3_f32 v184, v184, v214, v215
    v_max3_f32 v185, v185, v216, v217
    v_min3_f32 v186, v186, v214, v215
    v_min3_f32 v187, v187, v216, v217
    v_max3_f32 v184, v184, v218, v219
    v_max3_f32 v185, v185, v220, v221
    v_min3_f32 v186, v186, v218, v219
    v_min3_f32 v187, v187, v220, v221
    v_max_f32 v188, v184, v185
    v_max_f32 v184, v184, v185
    v_min_f32 v189, v186, v187
    v_min_f32 v186, v186, v187
    v_mov_b32 v190, 0x3fb8aa3b
    v_permlane32_swap_b32 v184, v188
    v_permlane32_swap_b32 v186, v189
    v_max_f32 v184, v184, v188
    v_min_f32 v186, v186, v189
    v_mul_f32 v184, v190, v184
    v_mul_f32 v186, v190, v186
    v_fma_f32 v152, v208, v190, -v184
    v_fma_f32 v168, -v208, v190, v186
    v_fma_f32 v153, v209, v190, -v184
    v_fma_f32 v169, -v209, v190, v186
    v_exp_f32 v152, v152
    v_exp_f32 v168, v168
    v_fma_f32 v154, v210, v190, -v184
    v_fma_f32 v170, -v210, v190, v186
    v_exp_f32 v153, v153
    v_exp_f32 v169, v169
    v_fma_f32 v155, v211, v190, -v184
    v_fma_f32 v171, -v211, v190, v186
    v_exp_f32 v154, v154
    v_exp_f32 v170, v170
    v_fma_f32 v156, v212, v190, -v184
    v_fma_f32 v172, -v212, v190, v186
    v_exp_f32 v155, v155
    v_exp_f32 v171, v171
    v_fma_f32 v157, v213, v190, -v184
    v_fma_f32 v173, -v213, v190, v186
    v_exp_f32 v156, v156
    v_exp_f32 v172, v172
    v_fma_f32 v158, v214, v190, -v184
    v_fma_f32 v174, -v214, v190, v186
    v_exp_f32 v157, v157
    v_exp_f32 v173, v173
    v_fma_f32 v159, v215, v190, -v184
    v_fma_f32 v175, -v215, v190, v186
    v_exp_f32 v158, v158
    v_exp_f32 v174, v174
    v_fma_f32 v160, v216, v190, -v184
    v_fma_f32 v176, -v216, v190, v186
    v_exp_f32 v159, v159
    v_exp_f32 v175, v175
    v_fma_f32 v161, v217, v190, -v184
    v_fma_f32 v177, -v217, v190, v186
    v_exp_f32 v160, v160
    v_exp_f32 v176, v176
    v_fma_f32 v162, v218, v190, -v184
    v_fma_f32 v178, -v218, v190, v186
    v_exp_f32 v161, v161
    v_exp_f32 v177, v177
    v_fma_f32 v163, v219, v190, -v184
    v_fma_f32 v179, -v219, v190, v186
    v_exp_f32 v162, v162
    v_exp_f32 v178, v178
    v_fma_f32 v164, v220, v190, -v184
    v_fma_f32 v180, -v220, v190, v186
    v_exp_f32 v163, v163
    v_exp_f32 v179, v179
    v_fma_f32 v165, v221, v190, -v184
    v_fma_f32 v181, -v221, v190, v186
    v_exp_f32 v164, v164
    v_exp_f32 v180, v180
    v_exp_f32 v165, v165
    v_exp_f32 v181, v181
.p2align 3
    v_cvt_pk_bf16_f32 v208, v152, v153
    v_cvt_pk_bf16_f32 v209, v154, v155
    v_cvt_pk_bf16_f32 v210, v156, v157
    v_cvt_pk_bf16_f32 v211, v158, v159
    v_cvt_pk_bf16_f32 v212, v160, v161
    v_cvt_pk_bf16_f32 v213, v162, v163
    v_cvt_pk_bf16_f32 v214, v164, v165
.p2align 3
    v_cvt_pk_bf16_f32 v216, v168, v169
    v_cvt_pk_bf16_f32 v217, v170, v171
    v_cvt_pk_bf16_f32 v218, v172, v173
    v_cvt_pk_bf16_f32 v219, v174, v175
    v_cvt_pk_bf16_f32 v220, v176, v177
    v_cvt_pk_bf16_f32 v221, v178, v179
    v_cvt_pk_bf16_f32 v222, v180, v181
    v_mov_b32 v215, 0
    v_mov_b32 v223, 0
    s_lshl_b32 s61, s55, 12
    s_add_u32 s61, s61, 65536
    s_lshl_b32 s65, s56, 1
    s_lshr_b32 s66, s48, 1
    s_add_u32 s65, s65, s66
    s_lshl_b32 s65, s65, 4
    s_add_u32 s65, s65, s55
    s_lshl_b32 s65, s65, 2
    s_and_b32 s66, s48, 1
    s_add_u32 s65, s65, s66
    s_lshl_b32 s65, s65, 10
    s_add_u32 s65, s65, 9437184
    s_lshl_b32 s64, s56, 4
    s_add_u32 s64, s64, s55
    s_lshl_b32 s64, s64, 7
    s_add_u32 s64, s64, 393216
    s_cmp_eq_u32 s59, 0
    s_cbranch_scc1 L_redo
    v_min_u32 v245, 6, v0
    v_lshlrev_b32 v245, 7, v245
    v_and_b32 v246, 3, v0
    v_lshlrev_b32 v246, 7, v246
    s_lshl_b32 s62, s58, 5
    s_mul_i32 s66, s48, 7
    s_add_u32 s62, s62, s66
    s_lshl_b32 s62, s62, 7
    s_add_u32 s62, s62, 327680
    s_and_b32 s63, s48, 1
    s_lshl_b32 s60, s57, 1
    s_add_u32 s60, s60, s63
    s_lshl_b32 s60, s60, 5
    s_lshl_b32 s61, s60, 1
    s_mul_i32 s60, s60, 896
    s_lshr_b32 s66, s48, 1
    s_lshl_b32 s63, s58, 1
    s_add_u32 s63, s63, s66
    s_lshl_b32 s63, s63, 6
    s_add_u32 s60, s60, s63
    v_lshlrev_b32 v247, 1, v241
    v_mul_u32_u24 v244, 896, v241
    v_lshl_add_u32 v244, v240, 4, v244
    buffer_load_dwordx4 v[224:227], v244, s[8:11], s60 offen offset:0
    buffer_load_dwordx4 v[228:231], v244, s[8:11], s60 offen offset:32
    buffer_load_ushort v232, v247, s[36:39], s61 offen
    s_lshl_b32 s61, s55, 12
    s_add_u32 s61, s61, 65536
    s_lshl_b32 s65, s56, 1
    s_lshr_b32 s66, s48, 1
    s_add_u32 s65, s65, s66
    s_lshl_b32 s65, s65, 4
    s_add_u32 s65, s65, s55
    s_lshl_b32 s65, s65, 2
    s_and_b32 s66, s48, 1
    s_add_u32 s65, s65, s66
    s_lshl_b32 s65, s65, 10
    s_add_u32 s65, s65, 9437184
    s_lshl_b32 s64, s56, 4
    s_add_u32 s64, s64, s55
    s_lshl_b32 s64, s64, 7
    s_add_u32 s64, s64, 393216
    s_lshr_b32 s69, s48, 1
    s_and_b32 s69, s69, 1
    s_lshl_b32 s69, s69, 10
    v_add_u32 v6, s69, v1
    v_xor_b32 v7, 0x400, v6
    s_mul_i32 s63, s58, 112
    s_mul_i32 s66, s48, 28
    s_add_u32 s63, s63, s66
    s_lshl_b32 s63, s63, 11
    s_add_u32 s63, s63, 7340032
    s_mul_i32 s73, s58, 4
    s_sub_u32 s73, 28, s73
    s_mul_i32 s5, s58, 8192
    s_add_u32 s5, s5, s63
    s_sub_u32 s6, s5, 57344
    s_lshl_b32 s63, s57, 2
    s_add_u32 s63, s63, s48
    s_lshl_b32 s63, s63, 14
    s_add_u32 s63, s63, 9437184
    s_lshr_b32 s66, s57, 1
    s_lshl_b32 s66, s66, 2
    s_add_u32 s66, s66, s48
    s_lshl_b32 s66, s66, 9
    s_add_u32 s66, s66, 393216
    s_waitcnt vmcnt(0) lgkmcnt(0)
    v_mov_b32 v12, 0
    s_cmp_lg_u32 s48, 0
    s_cbranch_scc1 L_wp_22
    buffer_load_dword v250, v12, s[44:47], s62 offen sc1
    s_waitcnt vmcnt(0)
    s_mov_b32 s74, 200000
L_poll_23:
    v_cmp_ne_u32 vcc, s51, v250
    s_nop 1
    s_cmp_eq_u64 vcc, 0
    s_cbranch_scc1 L_pdone_24
    s_sleep 4
    buffer_load_dword v250, v12, s[44:47], s62 offen sc1
    s_waitcnt vmcnt(0)
    s_sub_u32 s74, s74, 1
    s_cmp_lg_u32 s74, 0
    s_cbranch_scc1 L_poll_23
L_pdone_24:
L_wp_22:
    s_barrier
    buffer_load_dword v251, v245, s[44:47], s62 offen sc1
    buffer_load_dword v250, v243, s[44:47], s67 offen sc1
    s_waitcnt vmcnt(0)
    s_branch L_join
L_redo:
    s_cmp_lg_u32 s48, 0
    s_cbranch_scc1 L_wp_25
    buffer_load_dword v250, v243, s[44:47], s67 offen sc1
    s_waitcnt vmcnt(0)
    s_mov_b32 s74, 200000
L_poll_26:
    v_cmp_ne_u32 vcc, s51, v250
    s_nop 1
    s_cmp_eq_u64 vcc, 0
    s_cbranch_scc1 L_pdone_27
    s_sleep 4
    buffer_load_dword v250, v243, s[44:47], s67 offen sc1
    s_waitcnt vmcnt(0)
    s_sub_u32 s74, s74, 1
    s_cmp_lg_u32 s74, 0
    s_cbranch_scc1 L_poll_26
L_pdone_27:
L_wp_25:
    s_barrier
    buffer_load_dwordx4 v[160:163], v1, s[44:47], s61 offen offset:0 sc1
    buffer_load_dwordx4 v[164:167], v1, s[44:47], s61 offen offset:1024 sc1
    buffer_load_dwordx4 v[168:171], v1, s[44:47], s61 offen offset:2048 sc1
    buffer_load_dwordx4 v[172:175], v1, s[44:47], s61 offen offset:3072 sc1
    s_waitcnt vmcnt(0)
    v_mfma_f32_32x32x16_bf16 v[176:191], v[160:163], v[208:211], 0
    v_mfma_f32_32x32x16_bf16 v[192:207], v[168:171], v[216:219], 0
    v_mfma_f32_32x32x16_bf16 v[176:191], v[164:167], v[212:215], v[176:191]
    v_mfma_f32_32x32x16_bf16 v[192:207], v[172:175], v[220:223], v[192:207]
    s_nop 10
    v_rcp_f32 v80, v189
    v_rcp_f32 v81, v205
    v_mov_b32 v84, 0x358637bd
    v_fma_f32 v84, v188, v80, v84
    v_fma_f32 v84, v204, v81, v84
    v_rcp_f32 v84, v84
    v_cndmask_b32 v188, v188, 0, s[70:71]
    v_cndmask_b32 v204, v204, 0, s[70:71]
    v_cndmask_b32 v189, v189, 0, s[70:71]
    v_cndmask_b32 v205, v205, 0, s[70:71]
    v_mul_f32 v80, v80, v84
    v_mul_f32 v81, v81, v84
    v_mov_b32 v82, v80
    v_mov_b32 v86, v81
    s_nop 0
    v_permlane32_swap_b32 v80, v82
    v_permlane32_swap_b32 v81, v86
.p2align 3
    v_pk_mul_f32 v[176:177], v[176:177], v[82:83] op_sel_hi:[1,0]
    v_pk_mul_f32 v[178:179], v[178:179], v[82:83] op_sel_hi:[1,0]
    v_pk_mul_f32 v[180:181], v[180:181], v[82:83] op_sel_hi:[1,0]
    v_pk_mul_f32 v[182:183], v[182:183], v[82:83] op_sel_hi:[1,0]
    v_pk_mul_f32 v[184:185], v[184:185], v[82:83] op_sel_hi:[1,0]
    v_pk_mul_f32 v[186:187], v[186:187], v[82:83] op_sel_hi:[1,0]
    v_pk_mul_f32 v[188:189], v[188:189], v[82:83] op_sel_hi:[1,0]
    v_pk_mul_f32 v[190:191], v[190:191], v[82:83] op_sel_hi:[1,0]
.p2align 3
    v_pk_fma_f32 v[176:177], v[192:193], v[86:87], v[176:177] op_sel_hi:[1,0,1]
    v_pk_fma_f32 v[178:179], v[194:195], v[86:87], v[178:179] op_sel_hi:[1,0,1]
    v_pk_fma_f32 v[180:181], v[196:197], v[86:87], v[180:181] op_sel_hi:[1,0,1]
    v_pk_fma_f32 v[182:183], v[198:199], v[86:87], v[182:183] op_sel_hi:[1,0,1]
    v_pk_fma_f32 v[184:185], v[200:201], v[86:87], v[184:185] op_sel_hi:[1,0,1]
    v_pk_fma_f32 v[186:187], v[202:203], v[86:87], v[186:187] op_sel_hi:[1,0,1]
    v_pk_fma_f32 v[188:189], v[204:205], v[86:87], v[188:189] op_sel_hi:[1,0,1]
    v_pk_fma_f32 v[190:191], v[206:207], v[86:87], v[190:191] op_sel_hi:[1,0,1]
.p2align 3
    v_cvt_pk_bf16_f32 v88, v176, v177
    v_cvt_pk_bf16_f32 v89, v178, v179
    v_cvt_pk_bf16_f32 v90, v180, v181
    v_cvt_pk_bf16_f32 v91, v182, v183
    v_cvt_pk_bf16_f32 v92, v184, v185
    v_cvt_pk_bf16_f32 v93, v186, v187
    v_cvt_pk_bf16_f32 v94, v188, v189
    v_cvt_pk_bf16_f32 v95, v190, v191
    buffer_store_dwordx4 v[88:91], v1, s[44:47], s65 offen offset:0 sc1
    buffer_store_dwordx4 v[92:95], v1, s[44:47], s65 offen offset:2048 sc1
    s_waitcnt vmcnt(0) lgkmcnt(0)
    s_barrier
    s_cmp_lg_u32 s48, 0
    s_cbranch_scc1 L_wf_28
    v_mov_b32 v249, s51
    v_mov_b32 v248, 0
    s_mov_b64 exec, 1
    buffer_store_dword v249, v248, s[44:47], s64 offen sc1
    s_mov_b64 exec, -1
L_wf_28:
    s_branch L_fin
L_end:
    s_endpgm

.section .rodata,"a"
.p2align 6
.amdhsa_kernel parallel_sum__linear_kernel_hedgehog__mixer_token_mlp__prompt_kernel
  .amdhsa_next_free_vgpr 512
  .amdhsa_next_free_sgpr 102
  .amdhsa_accum_offset 256
  .amdhsa_group_segment_fixed_size 0
  .amdhsa_kernarg_size 96
  .amdhsa_user_sgpr_count 2
  .amdhsa_user_sgpr_kernarg_segment_ptr 1
  .amdhsa_system_sgpr_workgroup_id_x 1
  .amdhsa_float_denorm_mode_32 3
.end_amdhsa_kernel
```
